```python
import torch

def _softmax(x, axis=-1):
    return torch.softmax(x, dim=axis)
def _gelu(x):
    return torch.nn.functional.gelu(x, approximate="tanh")
def _silu(x):
    return torch.nn.functional.silu(x)
def _sigmoid(x):
    return torch.sigmoid(x)
def _layernorm(x, axis=-1, eps=1e-5):
    m = x.mean(dim=axis, keepdim=True)
    v = x.var(dim=axis, keepdim=True, unbiased=False)
    return (x - m) / torch.sqrt(v + eps)
def _scatter_add(tgt, idx, src, axis=0):
    return tgt.clone().index_add_(axis, idx, src)
def _segment_sum(src, seg, n):
    out = torch.zeros((n,) + src.shape[1:], dtype=src.dtype)
    return out.index_add_(0, seg, src)
def _pad(x, pw):
    flat = tuple(v for pair in reversed(pw) for v in pair)
    return torch.nn.functional.pad(x, flat)

kernel_name = 'gated_mix__mha_block__mixer_s_mlp__prompt'

def setup_inputs():

    _w = (lambda a: (lambda t: t.to(torch.bfloat16) if t.is_floating_point() else t)(torch.as_tensor(a)))
    def _A_setup():
        B, S, D, H = 1, 2048, 448, 16
        return {
            "x": _w((lambda *s: torch.randn(*s, dtype=torch.bfloat16) * 0.1)(B, S, D)),
            "wqkv": _w((lambda *s: torch.randn(*s, dtype=torch.bfloat16) * 0.8)(D, 3 * D)),
            "wo": _w((lambda *s: torch.randn(*s, dtype=torch.bfloat16) * 0.4)(D, D)),
        }
    _A_in = _A_setup()

    def _B_setup():
        B, S, D, F = 1, 2048, 448, 1792
        return {
            "x":  _w((lambda *s: torch.randn(*s, dtype=torch.bfloat16) * 0.1)(B, S, D)),
            "w1": _w((lambda *s: torch.randn(*s, dtype=torch.bfloat16) * 3.2)(D, D) * (D ** -0.5)),
            "w2": _w((lambda *s: torch.randn(*s, dtype=torch.bfloat16) * 3.2)(D, D) * (D ** -0.5)),
            "w3": _w((lambda *s: torch.randn(*s, dtype=torch.bfloat16) * 3.2)(D, F) * (D ** -0.5)),
            "w4": _w((lambda *s: torch.randn(*s, dtype=torch.bfloat16) * 3.2)(F, D) * (F ** -0.5)),
        }
    _B_in = _B_setup()

    return {
        "A_x": _A_in["x"],
        "A_wqkv": _A_in["wqkv"],
        "A_wo": _A_in["wo"],
        "B_x": _B_in["x"],
        "B_w1": _B_in["w1"],
        "B_w2": _B_in["w2"],
        "B_w3": _B_in["w3"],
        "B_w4": _B_in["w4"],
        "gate_w": _w((lambda *s: torch.randn(*s, dtype=torch.bfloat16) * 0.1)(448) * 16.0),
    }

def reference(A_x, A_wqkv, A_wo, B_x, B_w1, B_w2, B_w3, B_w4, gate_w):
    def _A_ref(x, wqkv, wo):
        B, S, D = x.shape
        H = 16
        Dh = D // H
        qkv = (lambda x, *d: x.permute(*d))((x @ wqkv).reshape(B, S, 3, H, Dh), 2, 0, 3, 1, 4)
        q, k, v = qkv[0], qkv[1], qkv[2]
        scores = torch.einsum("bhqd,bhkd->bhqk", q, k) * (Dh ** -0.5)
        p = _softmax(scores, axis=-1)
        o = torch.einsum("bhqk,bhkd->bhqd", p, v)
        return (lambda x, *d: x.permute(*d))(o, 0, 2, 1, 3).reshape(B, S, D) @ wo

    def _B_ref(x, w1, w2, w3, w4):
        B, S, D = x.shape
        h = _gelu(_layernorm(x, axis=-1) @ w1)
        c = D // 4
        g0 = _pad(h[:, :, 0*c:1*c], ((0, 0), (1, 0), (0, 0)))[:, :S, :]
        g1 = _pad(h[:, :, 1*c:2*c], ((0, 0), (0, 1), (0, 0)))[:, 1:, :]
        g2 = _pad(h[:, :, 2*c:3*c], ((0, 0), (2, 0), (0, 0)))[:, :S, :]
        g3 = _pad(h[:, :, 3*c:   ], ((0, 0), (0, 2), (0, 0)))[:, 2:, :]
        hs = torch.concatenate([g0, g1, g2, g3], axis=-1) @ w2
        x1 = x + hs
        h2 = _gelu(_layernorm(x1, axis=-1) @ w3) @ w4
        return x1 + h2

    x = A_x
    g = _sigmoid((x * gate_w).sum(-1, keepdims=True))
    a = _A_ref(x, A_wqkv, A_wo)
    b = _B_ref(x, B_w1, B_w2, B_w3, B_w4)
    return g * a + (1 - g) * b
```

```asm
; @launch kernel=k1_kernel grid=(256,1,1) block=(768,1,1) lds=156928
.amdgcn_target "amdgcn-amd-amdhsa--gfx950"
.text
.globl k1_kernel
.p2align 8
.type k1_kernel,@function
k1_kernel:
    s_cmp_ge_u32 s2, 256
    s_cbranch_scc1 K1_exit
    s_load_dwordx16 s[16:31], s[0:1], 0
    s_load_dwordx8 s[32:39], s[0:1], 64
    v_and_b32 v1, 63, v0
    v_lshrrev_b32 v2, 5, v1
    v_and_b32 v3, 31, v1
    v_bfe_u32 v17, v1, 2, 2
    v_mul_u32_u24 v18, 8, v2
    v_add_u32 v17, v17, v18
    v_lshlrev_b32 v4, 6, v17
    v_bfe_u32 v17, v1, 4, 1
    v_lshlrev_b32 v17, 5, v17
    v_and_b32 v18, 3, v1
    v_lshlrev_b32 v18, 3, v18
    v_add3_u32 v4, v4, v17, v18
    v_lshrrev_b32 v17, 6, v0
    s_nop 0
    v_readfirstlane_b32 s60, v17
    s_and_b32 s90, s2, 3
    s_bfe_u32 s91, s2, 0x10002
    s_lshr_b32 s92, s2, 3
    s_memrealtime s[88:89]
    s_waitcnt lgkmcnt(0)
    s_mov_b32 s85, 0
    s_cmp_lt_u32 s92, 24
    s_cbranch_scc1 K1_qkv
    s_mov_b32 s40, s16
    s_mov_b32 s41, s17
    s_mov_b32 s42, 1835008
    s_mov_b32 s43, 0x00020000
    s_mov_b32 s52, s32
    s_mov_b32 s53, s33
    s_mov_b32 s54, 896
    s_mov_b32 s55, 0x00020000
    s_mov_b32 s48, s38
    s_mov_b32 s49, s39
    s_mov_b32 s50, 33554432
    s_mov_b32 s51, 0x00020000
    s_lshl_b32 s65, s90, 3
    s_add_u32 s65, s65, s92
    s_sub_u32 s65, s65, 24
    s_mov_b32 s66, s91
    s_lshl_b32 s94, s65, 3
    s_lshl_b32 s61, s66, 2
    s_add_u32 s94, s94, s61
    s_add_u32 s94, s94, 24186880
    s_cmp_lt_u32 s60, 8
    s_cbranch_scc1 K1_w1_ln
    s_mov_b32 s44, s24
    s_mov_b32 s45, s25
    s_mov_b32 s46, 401408
    s_mov_b32 s47, 0x00020000
    s_sub_u32 s62, s60, 8
    s_lshl_b32 s63, s62, 10
    s_mul_i32 s64, s62, 14336
    s_mul_i32 s62, s66, 448
    s_add_u32 s64, s64, s62
    v_lshrrev_b32 v19, 2, v1
    v_mul_u32_u24 v19, 896, v19
    v_and_b32 v5, 3, v1
    v_lshl_add_u32 v5, v5, 4, v19
    s_add_u32 m0, s63, 57344
    s_add_u32 s61, s64, 0
    buffer_load_dwordx4 v5, s[44:47], s61 offen lds
    s_add_u32 m0, s63, 61440
    s_add_u32 s61, s64, 64
    buffer_load_dwordx4 v5, s[44:47], s61 offen lds
    s_add_u32 m0, s63, 65536
    s_add_u32 s61, s64, 256
    buffer_load_dwordx4 v5, s[44:47], s61 offen lds
    s_add_u32 m0, s63, 69632
    s_add_u32 s61, s64, 320
    buffer_load_dwordx4 v5, s[44:47], s61 offen lds
    s_add_u32 m0, s63, 73728
    s_add_u32 s61, s64, 57344
    buffer_load_dwordx4 v5, s[44:47], s61 offen lds
    s_add_u32 m0, s63, 77824
    s_add_u32 s61, s64, 57408
    buffer_load_dwordx4 v5, s[44:47], s61 offen lds
    s_add_u32 m0, s63, 81920
    s_add_u32 s61, s64, 57600
    buffer_load_dwordx4 v5, s[44:47], s61 offen lds
    s_add_u32 m0, s63, 86016
    s_add_u32 s61, s64, 57664
    buffer_load_dwordx4 v5, s[44:47], s61 offen lds
    s_add_u32 m0, s63, 90112
    s_add_u32 s61, s64, 114688
    buffer_load_dwordx4 v5, s[44:47], s61 offen lds
    s_add_u32 m0, s63, 94208
    s_add_u32 s61, s64, 114752
    buffer_load_dwordx4 v5, s[44:47], s61 offen lds
    s_add_u32 m0, s63, 98304
    s_add_u32 s61, s64, 114944
    buffer_load_dwordx4 v5, s[44:47], s61 offen lds
    s_add_u32 m0, s63, 102400
    s_add_u32 s61, s64, 115008
    buffer_load_dwordx4 v5, s[44:47], s61 offen lds
    s_add_u32 m0, s63, 106496
    s_add_u32 s61, s64, 172032
    buffer_load_dwordx4 v5, s[44:47], s61 offen lds
    s_add_u32 m0, s63, 110592
    s_add_u32 s61, s64, 172096
    buffer_load_dwordx4 v5, s[44:47], s61 offen lds
    s_add_u32 m0, s63, 114688
    s_add_u32 s61, s64, 172288
    buffer_load_dwordx4 v5, s[44:47], s61 offen lds
    s_add_u32 m0, s63, 118784
    s_add_u32 s61, s64, 172352
    buffer_load_dwordx4 v5, s[44:47], s61 offen lds
    s_add_u32 m0, s63, 122880
    s_add_u32 s61, s64, 229376
    buffer_load_dwordx4 v5, s[44:47], s61 offen lds
    s_add_u32 m0, s63, 126976
    s_add_u32 s61, s64, 229440
    buffer_load_dwordx4 v5, s[44:47], s61 offen lds
    s_add_u32 m0, s63, 131072
    s_add_u32 s61, s64, 229632
    buffer_load_dwordx4 v5, s[44:47], s61 offen lds
    s_add_u32 m0, s63, 135168
    s_add_u32 s61, s64, 229696
    buffer_load_dwordx4 v5, s[44:47], s61 offen lds
    s_add_u32 m0, s63, 139264
    s_add_u32 s61, s64, 286720
    buffer_load_dwordx4 v5, s[44:47], s61 offen lds
    s_add_u32 m0, s63, 143360
    s_add_u32 s61, s64, 286784
    buffer_load_dwordx4 v5, s[44:47], s61 offen lds
    s_add_u32 m0, s63, 147456
    s_add_u32 s61, s64, 286976
    buffer_load_dwordx4 v5, s[44:47], s61 offen lds
    s_add_u32 m0, s63, 151552
    s_add_u32 s61, s64, 287040
    buffer_load_dwordx4 v5, s[44:47], s61 offen lds
    s_waitcnt vmcnt(20)
    s_barrier
    s_waitcnt vmcnt(16)
    s_barrier
    s_waitcnt vmcnt(12)
    s_barrier
    s_add_u32 m0, s63, 57344
    s_add_u32 s61, s64, 344064
    buffer_load_dwordx4 v5, s[44:47], s61 offen lds
    s_add_u32 m0, s63, 61440
    s_add_u32 s61, s64, 344128
    buffer_load_dwordx4 v5, s[44:47], s61 offen lds
    s_add_u32 m0, s63, 65536
    s_add_u32 s61, s64, 344320
    buffer_load_dwordx4 v5, s[44:47], s61 offen lds
    s_add_u32 m0, s63, 69632
    s_add_u32 s61, s64, 344384
    buffer_load_dwordx4 v5, s[44:47], s61 offen lds
    s_waitcnt vmcnt(12)
    s_barrier
    s_add_u32 m0, s63, 73728
    s_add_u32 s61, s64, 128
    buffer_load_dwordx4 v5, s[44:47], s61 offen lds
    s_add_u32 m0, s63, 77824
    s_add_u32 s61, s64, 192
    buffer_load_dwordx4 v5, s[44:47], s61 offen lds
    s_add_u32 m0, s63, 81920
    s_add_u32 s61, s64, 384
    buffer_load_dwordx4 v5, s[44:47], s61 offen lds
    s_waitcnt vmcnt(11)
    s_barrier
    s_add_u32 m0, s63, 90112
    s_add_u32 s61, s64, 57472
    buffer_load_dwordx4 v5, s[44:47], s61 offen lds
    s_add_u32 m0, s63, 94208
    s_add_u32 s61, s64, 57536
    buffer_load_dwordx4 v5, s[44:47], s61 offen lds
    s_add_u32 m0, s63, 98304
    s_add_u32 s61, s64, 57728
    buffer_load_dwordx4 v5, s[44:47], s61 offen lds
    s_waitcnt vmcnt(10)
    s_barrier
    s_add_u32 m0, s63, 106496
    s_add_u32 s61, s64, 114816
    buffer_load_dwordx4 v5, s[44:47], s61 offen lds
    s_add_u32 m0, s63, 110592
    s_add_u32 s61, s64, 114880
    buffer_load_dwordx4 v5, s[44:47], s61 offen lds
    s_add_u32 m0, s63, 114688
    s_add_u32 s61, s64, 115072
    buffer_load_dwordx4 v5, s[44:47], s61 offen lds
    s_waitcnt vmcnt(9)
    s_barrier
    s_add_u32 m0, s63, 122880
    s_add_u32 s61, s64, 172160
    buffer_load_dwordx4 v5, s[44:47], s61 offen lds
    s_add_u32 m0, s63, 126976
    s_add_u32 s61, s64, 172224
    buffer_load_dwordx4 v5, s[44:47], s61 offen lds
    s_add_u32 m0, s63, 131072
    s_add_u32 s61, s64, 172416
    buffer_load_dwordx4 v5, s[44:47], s61 offen lds
    s_waitcnt vmcnt(9)
    s_barrier
    s_add_u32 m0, s63, 139264
    s_add_u32 s61, s64, 229504
    buffer_load_dwordx4 v5, s[44:47], s61 offen lds
    s_add_u32 m0, s63, 143360
    s_add_u32 s61, s64, 229568
    buffer_load_dwordx4 v5, s[44:47], s61 offen lds
    s_add_u32 m0, s63, 147456
    s_add_u32 s61, s64, 229760
    buffer_load_dwordx4 v5, s[44:47], s61 offen lds
    s_waitcnt vmcnt(9)
    s_barrier
    s_add_u32 m0, s63, 57344
    s_add_u32 s61, s64, 286848
    buffer_load_dwordx4 v5, s[44:47], s61 offen lds
    s_add_u32 m0, s63, 61440
    s_add_u32 s61, s64, 286912
    buffer_load_dwordx4 v5, s[44:47], s61 offen lds
    s_add_u32 m0, s63, 65536
    s_add_u32 s61, s64, 287104
    buffer_load_dwordx4 v5, s[44:47], s61 offen lds
    s_waitcnt vmcnt(9)
    s_barrier
    s_add_u32 m0, s63, 73728
    s_add_u32 s61, s64, 344192
    buffer_load_dwordx4 v5, s[44:47], s61 offen lds
    s_add_u32 m0, s63, 77824
    s_add_u32 s61, s64, 344256
    buffer_load_dwordx4 v5, s[44:47], s61 offen lds
    s_add_u32 m0, s63, 81920
    s_add_u32 s61, s64, 344448
    buffer_load_dwordx4 v5, s[44:47], s61 offen lds
    s_waitcnt vmcnt(9)
    s_barrier
    s_waitcnt vmcnt(6)
    s_barrier
    s_waitcnt vmcnt(3)
    s_barrier
    s_waitcnt vmcnt(0)
    s_barrier
    s_barrier
    s_branch K12_mid
K1_w1_ln:
    s_lshl_b32 s61, s65, 6
    s_lshl_b32 s62, s60, 3
    s_add_u32 s61, s61, s62
    v_lshrrev_b32 v17, 3, v1
    v_add_u32 v18, s61, v17
    v_mul_u32_u24 v19, 896, v18
    v_and_b32 v6, 7, v1
    v_lshl_add_u32 v19, v6, 4, v19
    buffer_load_dwordx4 v[24:27], v19, s[40:43], 0 offen offset:0
    buffer_load_dwordx4 v[28:31], v19, s[40:43], 0 offen offset:128
    buffer_load_dwordx4 v[32:35], v19, s[40:43], 0 offen offset:256
    buffer_load_dwordx4 v[36:39], v19, s[40:43], 0 offen offset:384
    buffer_load_dwordx4 v[40:43], v19, s[40:43], 0 offen offset:512
    buffer_load_dwordx4 v[44:47], v19, s[40:43], 0 offen offset:640
    buffer_load_dwordx4 v[48:51], v19, s[40:43], 0 offen offset:768
    v_lshlrev_b32 v5, 4, v6
    buffer_load_dwordx4 v[52:55], v5, s[52:55], 0 offen offset:0
    buffer_load_dwordx4 v[56:59], v5, s[52:55], 0 offen offset:128
    buffer_load_dwordx4 v[60:63], v5, s[52:55], 0 offen offset:256
    buffer_load_dwordx4 v[64:67], v5, s[52:55], 0 offen offset:384
    buffer_load_dwordx4 v[68:71], v5, s[52:55], 0 offen offset:512
    buffer_load_dwordx4 v[72:75], v5, s[52:55], 0 offen offset:640
    buffer_load_dwordx4 v[76:79], v5, s[52:55], 0 offen offset:768
    s_lshl_b32 s61, s60, 2
    v_lshrrev_b32 v19, 4, v1
    v_add_u32 v19, s61, v19
    v_and_b32 v19, 7, v19
    v_xor_b32 v19, v19, v6
    v_lshlrev_b32 v19, 4, v19
    s_lshl_b32 s61, s60, 10
    v_lshl_add_u32 v19, v17, 7, v19
    v_add_u32 v19, s61, v19
    v_lshlrev_b32 v18, 2, v18
    s_mov_b32 s61, 0x3f803f80
    v_mov_b32 v20, 0
    v_mov_b32 v21, 0
    v_mov_b32 v22, 0
    s_waitcnt vmcnt(0)
    v_dot2_f32_bf16 v20, v24, s61, v20
    v_dot2_f32_bf16 v21, v24, v24, v21
    v_dot2_f32_bf16 v22, v24, v52, v22
    v_dot2_f32_bf16 v20, v25, s61, v20
    v_dot2_f32_bf16 v21, v25, v25, v21
    v_dot2_f32_bf16 v22, v25, v53, v22
    v_dot2_f32_bf16 v20, v26, s61, v20
    v_dot2_f32_bf16 v21, v26, v26, v21
    v_dot2_f32_bf16 v22, v26, v54, v22
    v_dot2_f32_bf16 v20, v27, s61, v20
    v_dot2_f32_bf16 v21, v27, v27, v21
    v_dot2_f32_bf16 v22, v27, v55, v22
    v_dot2_f32_bf16 v20, v28, s61, v20
    v_dot2_f32_bf16 v21, v28, v28, v21
    v_dot2_f32_bf16 v22, v28, v56, v22
    v_dot2_f32_bf16 v20, v29, s61, v20
    v_dot2_f32_bf16 v21, v29, v29, v21
    v_dot2_f32_bf16 v22, v29, v57, v22
    v_dot2_f32_bf16 v20, v30, s61, v20
    v_dot2_f32_bf16 v21, v30, v30, v21
    v_dot2_f32_bf16 v22, v30, v58, v22
    v_dot2_f32_bf16 v20, v31, s61, v20
    v_dot2_f32_bf16 v21, v31, v31, v21
    v_dot2_f32_bf16 v22, v31, v59, v22
    v_dot2_f32_bf16 v20, v32, s61, v20
    v_dot2_f32_bf16 v21, v32, v32, v21
    v_dot2_f32_bf16 v22, v32, v60, v22
    v_dot2_f32_bf16 v20, v33, s61, v20
    v_dot2_f32_bf16 v21, v33, v33, v21
    v_dot2_f32_bf16 v22, v33, v61, v22
    v_dot2_f32_bf16 v20, v34, s61, v20
    v_dot2_f32_bf16 v21, v34, v34, v21
    v_dot2_f32_bf16 v22, v34, v62, v22
    v_dot2_f32_bf16 v20, v35, s61, v20
    v_dot2_f32_bf16 v21, v35, v35, v21
    v_dot2_f32_bf16 v22, v35, v63, v22
    v_dot2_f32_bf16 v20, v36, s61, v20
    v_dot2_f32_bf16 v21, v36, v36, v21
    v_dot2_f32_bf16 v22, v36, v64, v22
    v_dot2_f32_bf16 v20, v37, s61, v20
    v_dot2_f32_bf16 v21, v37, v37, v21
    v_dot2_f32_bf16 v22, v37, v65, v22
    v_dot2_f32_bf16 v20, v38, s61, v20
    v_dot2_f32_bf16 v21, v38, v38, v21
    v_dot2_f32_bf16 v22, v38, v66, v22
    v_dot2_f32_bf16 v20, v39, s61, v20
    v_dot2_f32_bf16 v21, v39, v39, v21
    v_dot2_f32_bf16 v22, v39, v67, v22
    v_dot2_f32_bf16 v20, v40, s61, v20
    v_dot2_f32_bf16 v21, v40, v40, v21
    v_dot2_f32_bf16 v22, v40, v68, v22
    v_dot2_f32_bf16 v20, v41, s61, v20
    v_dot2_f32_bf16 v21, v41, v41, v21
    v_dot2_f32_bf16 v22, v41, v69, v22
    v_dot2_f32_bf16 v20, v42, s61, v20
    v_dot2_f32_bf16 v21, v42, v42, v21
    v_dot2_f32_bf16 v22, v42, v70, v22
    v_dot2_f32_bf16 v20, v43, s61, v20
    v_dot2_f32_bf16 v21, v43, v43, v21
    v_dot2_f32_bf16 v22, v43, v71, v22
    v_dot2_f32_bf16 v20, v44, s61, v20
    v_dot2_f32_bf16 v21, v44, v44, v21
    v_dot2_f32_bf16 v22, v44, v72, v22
    v_dot2_f32_bf16 v20, v45, s61, v20
    v_dot2_f32_bf16 v21, v45, v45, v21
    v_dot2_f32_bf16 v22, v45, v73, v22
    v_dot2_f32_bf16 v20, v46, s61, v20
    v_dot2_f32_bf16 v21, v46, v46, v21
    v_dot2_f32_bf16 v22, v46, v74, v22
    v_dot2_f32_bf16 v20, v47, s61, v20
    v_dot2_f32_bf16 v21, v47, v47, v21
    v_dot2_f32_bf16 v22, v47, v75, v22
    v_dot2_f32_bf16 v20, v48, s61, v20
    v_dot2_f32_bf16 v21, v48, v48, v21
    v_dot2_f32_bf16 v22, v48, v76, v22
    v_dot2_f32_bf16 v20, v49, s61, v20
    v_dot2_f32_bf16 v21, v49, v49, v21
    v_dot2_f32_bf16 v22, v49, v77, v22
    v_dot2_f32_bf16 v20, v50, s61, v20
    v_dot2_f32_bf16 v21, v50, v50, v21
    v_dot2_f32_bf16 v22, v50, v78, v22
    v_dot2_f32_bf16 v20, v51, s61, v20
    v_dot2_f32_bf16 v21, v51, v51, v21
    v_dot2_f32_bf16 v22, v51, v79, v22
    v_lshlrev_b32 v80, 16, v24
    v_and_b32 v81, 0xffff0000, v24
    v_lshlrev_b32 v82, 16, v25
    v_and_b32 v83, 0xffff0000, v25
    v_lshlrev_b32 v84, 16, v26
    v_and_b32 v85, 0xffff0000, v26
    v_lshlrev_b32 v86, 16, v27
    v_and_b32 v87, 0xffff0000, v27
    v_lshlrev_b32 v88, 16, v28
    v_and_b32 v89, 0xffff0000, v28
    v_lshlrev_b32 v90, 16, v29
    v_and_b32 v91, 0xffff0000, v29
    v_lshlrev_b32 v92, 16, v30
    v_and_b32 v93, 0xffff0000, v30
    v_lshlrev_b32 v94, 16, v31
    v_and_b32 v95, 0xffff0000, v31
    v_lshlrev_b32 v96, 16, v32
    v_and_b32 v97, 0xffff0000, v32
    v_lshlrev_b32 v98, 16, v33
    v_and_b32 v99, 0xffff0000, v33
    v_lshlrev_b32 v100, 16, v34
    v_and_b32 v101, 0xffff0000, v34
    v_lshlrev_b32 v102, 16, v35
    v_and_b32 v103, 0xffff0000, v35
    v_lshlrev_b32 v104, 16, v36
    v_and_b32 v105, 0xffff0000, v36
    v_lshlrev_b32 v106, 16, v37
    v_and_b32 v107, 0xffff0000, v37
    v_lshlrev_b32 v108, 16, v38
    v_and_b32 v109, 0xffff0000, v38
    v_lshlrev_b32 v110, 16, v39
    v_and_b32 v111, 0xffff0000, v39
    v_lshlrev_b32 v112, 16, v40
    v_and_b32 v113, 0xffff0000, v40
    v_lshlrev_b32 v114, 16, v41
    v_and_b32 v115, 0xffff0000, v41
    v_lshlrev_b32 v116, 16, v42
    v_and_b32 v117, 0xffff0000, v42
    v_lshlrev_b32 v118, 16, v43
    v_and_b32 v119, 0xffff0000, v43
    v_lshlrev_b32 v120, 16, v44
    v_and_b32 v121, 0xffff0000, v44
    v_lshlrev_b32 v122, 16, v45
    v_and_b32 v123, 0xffff0000, v45
    v_lshlrev_b32 v124, 16, v46
    v_and_b32 v125, 0xffff0000, v46
    v_lshlrev_b32 v126, 16, v47
    v_and_b32 v127, 0xffff0000, v47
    v_lshlrev_b32 v128, 16, v48
    v_and_b32 v129, 0xffff0000, v48
    v_lshlrev_b32 v130, 16, v49
    v_and_b32 v131, 0xffff0000, v49
    v_lshlrev_b32 v132, 16, v50
    v_and_b32 v133, 0xffff0000, v50
    v_lshlrev_b32 v134, 16, v51
    v_and_b32 v135, 0xffff0000, v51
    s_nop 1
    v_add_f32_dpp v20, v20, v20 quad_perm:[1,0,3,2] row_mask:0xf bank_mask:0xf
    s_nop 1
    v_add_f32_dpp v20, v20, v20 quad_perm:[2,3,0,1] row_mask:0xf bank_mask:0xf
    s_nop 1
    v_add_f32_dpp v20, v20, v20 row_half_mirror row_mask:0xf bank_mask:0xf
    s_nop 1
    v_add_f32_dpp v21, v21, v21 quad_perm:[1,0,3,2] row_mask:0xf bank_mask:0xf
    s_nop 1
    v_add_f32_dpp v21, v21, v21 quad_perm:[2,3,0,1] row_mask:0xf bank_mask:0xf
    s_nop 1
    v_add_f32_dpp v21, v21, v21 row_half_mirror row_mask:0xf bank_mask:0xf
    s_nop 1
    v_add_f32_dpp v22, v22, v22 quad_perm:[1,0,3,2] row_mask:0xf bank_mask:0xf
    s_nop 1
    v_add_f32_dpp v22, v22, v22 quad_perm:[2,3,0,1] row_mask:0xf bank_mask:0xf
    s_nop 1
    v_add_f32_dpp v22, v22, v22 row_half_mirror row_mask:0xf bank_mask:0xf
    v_mul_f32 v20, 991054117, v20
    v_mul_f32 v21, 991054117, v21
    v_fma_f32 v21, -v20, v20, v21
    v_add_f32 v21, 925353388, v21
    v_rsq_f32 v21, v21
    v_mul_f32 v22, 3216550459, v22
    v_mul_f32 v20, v20, v21
    v_exp_f32 v22, v22
    v_fma_f32 v80, v80, v21, -v20
    v_fma_f32 v81, v81, v21, -v20
    v_fma_f32 v82, v82, v21, -v20
    v_fma_f32 v83, v83, v21, -v20
    v_fma_f32 v84, v84, v21, -v20
    v_fma_f32 v85, v85, v21, -v20
    v_fma_f32 v86, v86, v21, -v20
    v_fma_f32 v87, v87, v21, -v20
    v_fma_f32 v88, v88, v21, -v20
    v_fma_f32 v89, v89, v21, -v20
    v_fma_f32 v90, v90, v21, -v20
    v_fma_f32 v91, v91, v21, -v20
    v_fma_f32 v92, v92, v21, -v20
    v_fma_f32 v93, v93, v21, -v20
    v_fma_f32 v94, v94, v21, -v20
    v_fma_f32 v95, v95, v21, -v20
    v_fma_f32 v96, v96, v21, -v20
    v_fma_f32 v97, v97, v21, -v20
    v_fma_f32 v98, v98, v21, -v20
    v_fma_f32 v99, v99, v21, -v20
    v_fma_f32 v100, v100, v21, -v20
    v_fma_f32 v101, v101, v21, -v20
    v_fma_f32 v102, v102, v21, -v20
    v_fma_f32 v103, v103, v21, -v20
    v_fma_f32 v104, v104, v21, -v20
    v_fma_f32 v105, v105, v21, -v20
    v_fma_f32 v106, v106, v21, -v20
    v_fma_f32 v107, v107, v21, -v20
    v_fma_f32 v108, v108, v21, -v20
    v_fma_f32 v109, v109, v21, -v20
    v_fma_f32 v110, v110, v21, -v20
    v_fma_f32 v111, v111, v21, -v20
    v_fma_f32 v112, v112, v21, -v20
    v_fma_f32 v113, v113, v21, -v20
    v_fma_f32 v114, v114, v21, -v20
    v_fma_f32 v115, v115, v21, -v20
    v_fma_f32 v116, v116, v21, -v20
    v_fma_f32 v117, v117, v21, -v20
    v_fma_f32 v118, v118, v21, -v20
    v_fma_f32 v119, v119, v21, -v20
    v_fma_f32 v120, v120, v21, -v20
    v_fma_f32 v121, v121, v21, -v20
    v_fma_f32 v122, v122, v21, -v20
    v_fma_f32 v123, v123, v21, -v20
    v_fma_f32 v124, v124, v21, -v20
    v_fma_f32 v125, v125, v21, -v20
    v_fma_f32 v126, v126, v21, -v20
    v_fma_f32 v127, v127, v21, -v20
    v_fma_f32 v128, v128, v21, -v20
    v_fma_f32 v129, v129, v21, -v20
    v_fma_f32 v130, v130, v21, -v20
    v_fma_f32 v131, v131, v21, -v20
    v_fma_f32 v132, v132, v21, -v20
    v_fma_f32 v133, v133, v21, -v20
    v_fma_f32 v134, v134, v21, -v20
    v_fma_f32 v135, v135, v21, -v20
    v_add_f32 v22, 1.0, v22
    v_rcp_f32 v22, v22
    v_cvt_pk_bf16_f32 v24, v80, v81
    v_cvt_pk_bf16_f32 v25, v82, v83
    v_cvt_pk_bf16_f32 v26, v84, v85
    v_cvt_pk_bf16_f32 v27, v86, v87
    v_cvt_pk_bf16_f32 v28, v88, v89
    v_cvt_pk_bf16_f32 v29, v90, v91
    v_cvt_pk_bf16_f32 v30, v92, v93
    v_cvt_pk_bf16_f32 v31, v94, v95
    v_cvt_pk_bf16_f32 v32, v96, v97
    v_cvt_pk_bf16_f32 v33, v98, v99
    v_cvt_pk_bf16_f32 v34, v100, v101
    v_cvt_pk_bf16_f32 v35, v102, v103
    v_cvt_pk_bf16_f32 v36, v104, v105
    v_cvt_pk_bf16_f32 v37, v106, v107
    v_cvt_pk_bf16_f32 v38, v108, v109
    v_cvt_pk_bf16_f32 v39, v110, v111
    v_cvt_pk_bf16_f32 v40, v112, v113
    v_cvt_pk_bf16_f32 v41, v114, v115
    v_cvt_pk_bf16_f32 v42, v116, v117
    v_cvt_pk_bf16_f32 v43, v118, v119
    v_cvt_pk_bf16_f32 v44, v120, v121
    v_cvt_pk_bf16_f32 v45, v122, v123
    v_cvt_pk_bf16_f32 v46, v124, v125
    v_cvt_pk_bf16_f32 v47, v126, v127
    v_cvt_pk_bf16_f32 v48, v128, v129
    v_cvt_pk_bf16_f32 v49, v130, v131
    v_cvt_pk_bf16_f32 v50, v132, v133
    v_cvt_pk_bf16_f32 v51, v134, v135
    ds_write_b128 v19, v[24:27] offset:0
    ds_write_b128 v19, v[28:31] offset:8192
    ds_write_b128 v19, v[32:35] offset:16384
    ds_write_b128 v19, v[36:39] offset:24576
    ds_write_b128 v19, v[40:43] offset:32768
    ds_write_b128 v19, v[44:47] offset:40960
    ds_write_b128 v19, v[48:51] offset:49152
    s_cmp_eq_u32 s66, 0
    s_cbranch_scc0 K1_w1_nog2
    s_mov_b32 s61, 8388608
    v_cmp_eq_u32 vcc, 0, v6
    s_and_saveexec_b64 s[58:59], vcc
    buffer_store_dword v22, v18, s[48:51], s61 offen sc1
    s_mov_b64 exec, s[58:59]
K1_w1_nog2:
    s_waitcnt lgkmcnt(0)
    s_lshr_b32 s69, s60, 2
    s_and_b32 s70, s60, 3
    s_and_b32 s61, s70, 1
    s_lshl_b32 s61, s61, 12
    v_lshlrev_b32 v17, 7, v3
    v_add_u32 v17, s61, v17
    v_bfe_u32 v18, v3, 1, 3
    v_add_u32 v19, 0, v2
    v_xor_b32 v19, v19, v18
    v_lshlrev_b32 v19, 4, v19
    v_add_u32 v8, v17, v19
    v_add_u32 v19, 2, v2
    v_xor_b32 v19, v19, v18
    v_lshlrev_b32 v19, 4, v19
    v_add_u32 v9, v17, v19
    v_add_u32 v19, 4, v2
    v_xor_b32 v19, v19, v18
    v_lshlrev_b32 v19, 4, v19
    v_add_u32 v10, v17, v19
    v_add_u32 v19, 6, v2
    v_xor_b32 v19, v19, v18
    v_lshlrev_b32 v19, 4, v19
    v_add_u32 v11, v17, v19
    s_lshr_b32 s61, s70, 1
    s_lshl_b32 s61, s61, 13
    s_add_u32 s61, s61, 57344
    v_add_u32 v4, s61, v4
    s_and_b32 s62, s70, 1
    s_lshl_b32 s68, s65, 1
    s_add_u32 s68, s68, s62
    s_mul_i32 s68, s68, 28672
    s_mul_i32 s61, s66, 14336
    s_add_u32 s68, s68, s61
    s_lshr_b32 s61, s70, 1
    s_lshl_b32 s61, s61, 13
    s_add_u32 s68, s68, s61
    s_lshl_b32 s61, s69, 12
    s_add_u32 s68, s68, s61
    s_add_u32 s68, s68, 6291456
    v_lshlrev_b32 v17, 4, v1
    s_mov_b32 s67, 3184710632
    v_mov_b32 v7, 3222493025
    s_mov_b32 s71, 0
    s_cmp_eq_u32 s69, 0
    s_cbranch_scc0 K1_w1_B
    s_mov_b32 s72, 0
    s_barrier
    v_add_u32 v12, s71, v8
    v_add_u32 v13, s71, v9
    v_add_u32 v14, s71, v10
    v_add_u32 v15, s71, v11
    v_add_u32 v16, s72, v4
    s_add_u32 s71, s71, 8192
    s_add_u32 s72, s72, 16384
    s_cmp_lt_u32 s72, 98304
    s_cselect_b32 s72, s72, 0
    v_mov_b32 v96, 0
    v_mov_b32 v97, 0
    v_mov_b32 v98, 0
    v_mov_b32 v99, 0
    v_mov_b32 v100, 0
    v_mov_b32 v101, 0
    v_mov_b32 v102, 0
    v_mov_b32 v103, 0
    v_mov_b32 v104, 0
    v_mov_b32 v105, 0
    v_mov_b32 v106, 0
    v_mov_b32 v107, 0
    v_mov_b32 v108, 0
    v_mov_b32 v109, 0
    v_mov_b32 v110, 0
    v_mov_b32 v111, 0
    v_mov_b32 v112, 0
    v_mov_b32 v113, 0
    v_mov_b32 v114, 0
    v_mov_b32 v115, 0
    v_mov_b32 v116, 0
    v_mov_b32 v117, 0
    v_mov_b32 v118, 0
    v_mov_b32 v119, 0
    v_mov_b32 v120, 0
    v_mov_b32 v121, 0
    v_mov_b32 v122, 0
    v_mov_b32 v123, 0
    v_mov_b32 v124, 0
    v_mov_b32 v125, 0
    v_mov_b32 v126, 0
    v_mov_b32 v127, 0
    ds_read_b128 v[24:27], v12
    ds_read_b64_tr_b16 v[40:41], v16 offset:0
    ds_read_b64_tr_b16 v[42:43], v16 offset:256
    ds_read_b64_tr_b16 v[44:45], v16 offset:4096
    ds_read_b64_tr_b16 v[46:47], v16 offset:4352
    ds_read_b128 v[28:31], v13
    ds_read_b64_tr_b16 v[48:49], v16 offset:1024
    ds_read_b64_tr_b16 v[50:51], v16 offset:1280
    ds_read_b64_tr_b16 v[52:53], v16 offset:5120
    ds_read_b64_tr_b16 v[54:55], v16 offset:5376
    s_mov_b32 s73, 0
.p2align 6
K1A_loop:
    ds_read_b128 v[32:35], v14
    ds_read_b64_tr_b16 v[56:57], v16 offset:2048
    ds_read_b64_tr_b16 v[58:59], v16 offset:2304
    ds_read_b64_tr_b16 v[60:61], v16 offset:6144
    ds_read_b64_tr_b16 v[62:63], v16 offset:6400
    s_waitcnt lgkmcnt(10)
    v_mfma_f32_32x32x16_bf16 v[96:111], v[40:43], v[24:27], v[96:111]
    v_mfma_f32_32x32x16_bf16 v[112:127], v[44:47], v[24:27], v[112:127]
    ds_read_b128 v[36:39], v15
    ds_read_b64_tr_b16 v[64:65], v16 offset:3072
    ds_read_b64_tr_b16 v[66:67], v16 offset:3328
    ds_read_b64_tr_b16 v[68:69], v16 offset:7168
    ds_read_b64_tr_b16 v[70:71], v16 offset:7424
    s_waitcnt lgkmcnt(10)
    v_mfma_f32_32x32x16_bf16 v[96:111], v[48:51], v[28:31], v[96:111]
    v_mfma_f32_32x32x16_bf16 v[112:127], v[52:55], v[28:31], v[112:127]
    s_barrier
    v_add_u32 v12, s71, v8
    v_add_u32 v13, s71, v9
    v_add_u32 v14, s71, v10
    v_add_u32 v15, s71, v11
    v_add_u32 v16, s72, v4
    s_add_u32 s71, s71, 8192
    s_add_u32 s72, s72, 16384
    s_cmp_lt_u32 s72, 98304
    s_cselect_b32 s72, s72, 0
    ds_read_b128 v[24:27], v12
    ds_read_b64_tr_b16 v[40:41], v16 offset:0
    ds_read_b64_tr_b16 v[42:43], v16 offset:256
    ds_read_b64_tr_b16 v[44:45], v16 offset:4096
    ds_read_b64_tr_b16 v[46:47], v16 offset:4352
    s_waitcnt lgkmcnt(10)
    v_mfma_f32_32x32x16_bf16 v[96:111], v[56:59], v[32:35], v[96:111]
    v_mfma_f32_32x32x16_bf16 v[112:127], v[60:63], v[32:35], v[112:127]
    ds_read_b128 v[28:31], v13
    ds_read_b64_tr_b16 v[48:49], v16 offset:1024
    ds_read_b64_tr_b16 v[50:51], v16 offset:1280
    ds_read_b64_tr_b16 v[52:53], v16 offset:5120
    ds_read_b64_tr_b16 v[54:55], v16 offset:5376
    s_waitcnt lgkmcnt(10)
    v_mfma_f32_32x32x16_bf16 v[96:111], v[64:67], v[36:39], v[96:111]
    v_mfma_f32_32x32x16_bf16 v[112:127], v[68:71], v[36:39], v[112:127]
    s_add_u32 s73, s73, 1
    s_cmp_lt_u32 s73, 7
    s_cbranch_scc1 K1A_loop
    s_waitcnt lgkmcnt(0)
    s_nop 10
    v_mul_f32 v72, v96, v96
    v_mul_f32 v73, v97, v97
    v_mul_f32 v74, v98, v98
    v_mul_f32 v75, v99, v99
    v_mul_f32 v76, v100, v100
    v_mul_f32 v77, v101, v101
    v_mul_f32 v78, v102, v102
    v_mul_f32 v79, v103, v103
    v_mul_f32 v80, v104, v104
    v_mul_f32 v81, v105, v105
    v_mul_f32 v82, v106, v106
    v_mul_f32 v83, v107, v107
    v_mul_f32 v84, v108, v108
    v_mul_f32 v85, v109, v109
    v_mul_f32 v86, v110, v110
    v_mul_f32 v87, v111, v111
    v_fma_f32 v72, v72, s67, v7
    v_fma_f32 v73, v73, s67, v7
    v_fma_f32 v74, v74, s67, v7
    v_fma_f32 v75, v75, s67, v7
    v_fma_f32 v76, v76, s67, v7
    v_fma_f32 v77, v77, s67, v7
    v_fma_f32 v78, v78, s67, v7
    v_fma_f32 v79, v79, s67, v7
    v_fma_f32 v80, v80, s67, v7
    v_fma_f32 v81, v81, s67, v7
    v_fma_f32 v82, v82, s67, v7
    v_fma_f32 v83, v83, s67, v7
    v_fma_f32 v84, v84, s67, v7
    v_fma_f32 v85, v85, s67, v7
    v_fma_f32 v86, v86, s67, v7
    v_fma_f32 v87, v87, s67, v7
    v_mul_f32 v72, v72, v96
    v_mul_f32 v73, v73, v97
    v_mul_f32 v74, v74, v98
    s_barrier
    v_mul_f32 v75, v75, v99
    v_mul_f32 v76, v76, v100
    v_mul_f32 v77, v77, v101
    v_mul_f32 v78, v78, v102
    v_mul_f32 v79, v79, v103
    v_mul_f32 v80, v80, v104
    v_mul_f32 v81, v81, v105
    v_mul_f32 v82, v82, v106
    v_mul_f32 v83, v83, v107
    v_mul_f32 v84, v84, v108
    v_mul_f32 v85, v85, v109
    v_mul_f32 v86, v86, v110
    v_mul_f32 v87, v87, v111
    v_exp_f32 v72, v72
    v_exp_f32 v73, v73
    v_exp_f32 v74, v74
    v_exp_f32 v75, v75
    v_exp_f32 v76, v76
    v_exp_f32 v77, v77
    v_exp_f32 v78, v78
    v_exp_f32 v79, v79
    v_exp_f32 v80, v80
    v_exp_f32 v81, v81
    v_exp_f32 v82, v82
    v_exp_f32 v83, v83
    v_exp_f32 v84, v84
    v_exp_f32 v85, v85
    v_exp_f32 v86, v86
    v_exp_f32 v87, v87
    v_add_f32 v72, 1.0, v72
    v_add_f32 v73, 1.0, v73
    v_add_f32 v74, 1.0, v74
    v_add_f32 v75, 1.0, v75
    v_add_f32 v76, 1.0, v76
    v_add_f32 v77, 1.0, v77
    v_add_f32 v78, 1.0, v78
    s_barrier
    v_add_f32 v79, 1.0, v79
    v_add_f32 v80, 1.0, v80
    v_add_f32 v81, 1.0, v81
    v_add_f32 v82, 1.0, v82
    v_add_f32 v83, 1.0, v83
    v_add_f32 v84, 1.0, v84
    v_add_f32 v85, 1.0, v85
    v_add_f32 v86, 1.0, v86
    v_add_f32 v87, 1.0, v87
    v_rcp_f32 v72, v72
    v_rcp_f32 v73, v73
    v_rcp_f32 v74, v74
    v_rcp_f32 v75, v75
    v_rcp_f32 v76, v76
    v_rcp_f32 v77, v77
    v_rcp_f32 v78, v78
    v_rcp_f32 v79, v79
    v_rcp_f32 v80, v80
    v_rcp_f32 v81, v81
    v_rcp_f32 v82, v82
    v_rcp_f32 v83, v83
    v_rcp_f32 v84, v84
    v_rcp_f32 v85, v85
    v_rcp_f32 v86, v86
    v_rcp_f32 v87, v87
    v_mul_f32 v96, v96, v72
    v_mul_f32 v97, v97, v73
    v_mul_f32 v98, v98, v74
    v_mul_f32 v99, v99, v75
    v_mul_f32 v100, v100, v76
    v_mul_f32 v101, v101, v77
    v_mul_f32 v102, v102, v78
    v_mul_f32 v103, v103, v79
    v_mul_f32 v104, v104, v80
    v_mul_f32 v105, v105, v81
    v_mul_f32 v106, v106, v82
    s_barrier
    v_mul_f32 v107, v107, v83
    v_mul_f32 v108, v108, v84
    v_mul_f32 v109, v109, v85
    v_mul_f32 v110, v110, v86
    v_mul_f32 v111, v111, v87
    v_cvt_pk_bf16_f32 v88, v96, v97
    v_cvt_pk_bf16_f32 v89, v98, v99
    v_cvt_pk_bf16_f32 v90, v100, v101
    v_cvt_pk_bf16_f32 v91, v102, v103
    v_cvt_pk_bf16_f32 v92, v104, v105
    v_cvt_pk_bf16_f32 v93, v106, v107
    v_cvt_pk_bf16_f32 v94, v108, v109
    v_cvt_pk_bf16_f32 v95, v110, v111
    buffer_store_dwordx4 v[88:91], v17, s[48:51], s68 offen offset:0 sc1
    buffer_store_dwordx4 v[92:95], v17, s[48:51], s68 offen offset:1024 sc1
    s_nop 1
    v_mul_f32 v72, v112, v112
    v_mul_f32 v73, v113, v113
    v_mul_f32 v74, v114, v114
    v_mul_f32 v75, v115, v115
    v_mul_f32 v76, v116, v116
    v_mul_f32 v77, v117, v117
    v_mul_f32 v78, v118, v118
    v_mul_f32 v79, v119, v119
    v_mul_f32 v80, v120, v120
    v_mul_f32 v81, v121, v121
    v_mul_f32 v82, v122, v122
    v_mul_f32 v83, v123, v123
    v_mul_f32 v84, v124, v124
    v_mul_f32 v85, v125, v125
    v_mul_f32 v86, v126, v126
    v_mul_f32 v87, v127, v127
    v_fma_f32 v72, v72, s67, v7
    v_fma_f32 v73, v73, s67, v7
    v_fma_f32 v74, v74, s67, v7
    v_fma_f32 v75, v75, s67, v7
    s_barrier
    v_fma_f32 v76, v76, s67, v7
    v_fma_f32 v77, v77, s67, v7
    v_fma_f32 v78, v78, s67, v7
    v_fma_f32 v79, v79, s67, v7
    v_fma_f32 v80, v80, s67, v7
    v_fma_f32 v81, v81, s67, v7
    v_fma_f32 v82, v82, s67, v7
    v_fma_f32 v83, v83, s67, v7
    v_fma_f32 v84, v84, s67, v7
    v_fma_f32 v85, v85, s67, v7
    v_fma_f32 v86, v86, s67, v7
    v_fma_f32 v87, v87, s67, v7
    v_mul_f32 v72, v72, v112
    v_mul_f32 v73, v73, v113
    v_mul_f32 v74, v74, v114
    v_mul_f32 v75, v75, v115
    v_mul_f32 v76, v76, v116
    v_mul_f32 v77, v77, v117
    v_mul_f32 v78, v78, v118
    v_mul_f32 v79, v79, v119
    v_mul_f32 v80, v80, v120
    v_mul_f32 v81, v81, v121
    v_mul_f32 v82, v82, v122
    v_mul_f32 v83, v83, v123
    v_mul_f32 v84, v84, v124
    v_mul_f32 v85, v85, v125
    v_mul_f32 v86, v86, v126
    v_mul_f32 v87, v87, v127
    v_exp_f32 v72, v72
    v_exp_f32 v73, v73
    v_exp_f32 v74, v74
    v_exp_f32 v75, v75
    v_exp_f32 v76, v76
    v_exp_f32 v77, v77
    v_exp_f32 v78, v78
    v_exp_f32 v79, v79
    s_barrier
    v_exp_f32 v80, v80
    v_exp_f32 v81, v81
    v_exp_f32 v82, v82
    v_exp_f32 v83, v83
    v_exp_f32 v84, v84
    v_exp_f32 v85, v85
    v_exp_f32 v86, v86
    v_exp_f32 v87, v87
    v_add_f32 v72, 1.0, v72
    v_add_f32 v73, 1.0, v73
    v_add_f32 v74, 1.0, v74
    v_add_f32 v75, 1.0, v75
    v_add_f32 v76, 1.0, v76
    v_add_f32 v77, 1.0, v77
    v_add_f32 v78, 1.0, v78
    v_add_f32 v79, 1.0, v79
    v_add_f32 v80, 1.0, v80
    v_add_f32 v81, 1.0, v81
    v_add_f32 v82, 1.0, v82
    v_add_f32 v83, 1.0, v83
    v_add_f32 v84, 1.0, v84
    v_add_f32 v85, 1.0, v85
    v_add_f32 v86, 1.0, v86
    v_add_f32 v87, 1.0, v87
    v_rcp_f32 v72, v72
    v_rcp_f32 v73, v73
    v_rcp_f32 v74, v74
    v_rcp_f32 v75, v75
    v_rcp_f32 v76, v76
    v_rcp_f32 v77, v77
    v_rcp_f32 v78, v78
    v_rcp_f32 v79, v79
    v_rcp_f32 v80, v80
    v_rcp_f32 v81, v81
    v_rcp_f32 v82, v82
    v_rcp_f32 v83, v83
    s_barrier
    v_rcp_f32 v84, v84
    v_rcp_f32 v85, v85
    v_rcp_f32 v86, v86
    v_rcp_f32 v87, v87
    v_mul_f32 v112, v112, v72
    v_mul_f32 v113, v113, v73
    v_mul_f32 v114, v114, v74
    v_mul_f32 v115, v115, v75
    v_mul_f32 v116, v116, v76
    v_mul_f32 v117, v117, v77
    v_mul_f32 v118, v118, v78
    v_mul_f32 v119, v119, v79
    v_mul_f32 v120, v120, v80
    v_mul_f32 v121, v121, v81
    v_mul_f32 v122, v122, v82
    v_mul_f32 v123, v123, v83
    v_mul_f32 v124, v124, v84
    v_mul_f32 v125, v125, v85
    v_mul_f32 v126, v126, v86
    v_mul_f32 v127, v127, v87
    v_cvt_pk_bf16_f32 v88, v112, v113
    v_cvt_pk_bf16_f32 v89, v114, v115
    v_cvt_pk_bf16_f32 v90, v116, v117
    v_cvt_pk_bf16_f32 v91, v118, v119
    v_cvt_pk_bf16_f32 v92, v120, v121
    v_cvt_pk_bf16_f32 v93, v122, v123
    v_cvt_pk_bf16_f32 v94, v124, v125
    v_cvt_pk_bf16_f32 v95, v126, v127
    buffer_store_dwordx4 v[88:91], v17, s[48:51], s68 offen offset:2048 sc1
    buffer_store_dwordx4 v[92:95], v17, s[48:51], s68 offen offset:3072 sc1
    s_nop 1
    s_barrier
    s_branch K12_mid
K1_w1_B:
    s_cmp_eq_u32 s60, 4
    s_cbranch_scc0 K1_notok2
    s_mov_b32 s56, s36
    s_mov_b32 s57, s37
    s_mov_b32 s58, 256
    s_mov_b32 s59, 0x00020000
    s_or_b32 s88, s88, 1
    s_mov_b32 s85, 1
    v_mov_b32 v158, s88
    v_mov_b32 v159, 0
    v_mov_b32 v157, 0
    v_cmp_eq_u32 vcc, 0, v1
    s_and_saveexec_b64 s[86:87], vcc
    buffer_atomic_cmpswap v[158:159], v157, s[56:59], 0 offen sc0 sc1
    s_mov_b64 exec, s[86:87]
K1_notok2:
    s_barrier
    s_barrier
    s_barrier
    s_barrier
    s_barrier
    s_barrier
    s_barrier
    s_barrier
    s_mov_b32 s72, 16384
    v_add_u32 v12, s71, v8
    v_add_u32 v13, s71, v9
    v_add_u32 v14, s71, v10
    v_add_u32 v15, s71, v11
    v_add_u32 v16, s72, v4
    s_add_u32 s71, s71, 8192
    s_add_u32 s72, s72, 16384
    s_cmp_lt_u32 s72, 98304
    s_cselect_b32 s72, s72, 0
    v_mov_b32 v96, 0
    v_mov_b32 v97, 0
    v_mov_b32 v98, 0
    v_mov_b32 v99, 0
    v_mov_b32 v100, 0
    v_mov_b32 v101, 0
    v_mov_b32 v102, 0
    v_mov_b32 v103, 0
    v_mov_b32 v104, 0
    v_mov_b32 v105, 0
    v_mov_b32 v106, 0
    v_mov_b32 v107, 0
    v_mov_b32 v108, 0
    v_mov_b32 v109, 0
    v_mov_b32 v110, 0
    v_mov_b32 v111, 0
    v_mov_b32 v112, 0
    v_mov_b32 v113, 0
    v_mov_b32 v114, 0
    v_mov_b32 v115, 0
    v_mov_b32 v116, 0
    v_mov_b32 v117, 0
    v_mov_b32 v118, 0
    v_mov_b32 v119, 0
    v_mov_b32 v120, 0
    v_mov_b32 v121, 0
    v_mov_b32 v122, 0
    v_mov_b32 v123, 0
    v_mov_b32 v124, 0
    v_mov_b32 v125, 0
    v_mov_b32 v126, 0
    v_mov_b32 v127, 0
    ds_read_b128 v[24:27], v12
    ds_read_b64_tr_b16 v[40:41], v16 offset:0
    ds_read_b64_tr_b16 v[42:43], v16 offset:256
    ds_read_b64_tr_b16 v[44:45], v16 offset:4096
    ds_read_b64_tr_b16 v[46:47], v16 offset:4352
    ds_read_b128 v[28:31], v13
    ds_read_b64_tr_b16 v[48:49], v16 offset:1024
    ds_read_b64_tr_b16 v[50:51], v16 offset:1280
    ds_read_b64_tr_b16 v[52:53], v16 offset:5120
    ds_read_b64_tr_b16 v[54:55], v16 offset:5376
    s_mov_b32 s73, 0
.p2align 6
K1B_loop:
    ds_read_b128 v[32:35], v14
    ds_read_b64_tr_b16 v[56:57], v16 offset:2048
    ds_read_b64_tr_b16 v[58:59], v16 offset:2304
    ds_read_b64_tr_b16 v[60:61], v16 offset:6144
    ds_read_b64_tr_b16 v[62:63], v16 offset:6400
    s_waitcnt lgkmcnt(10)
    v_mfma_f32_32x32x16_bf16 v[96:111], v[40:43], v[24:27], v[96:111]
    v_mfma_f32_32x32x16_bf16 v[112:127], v[44:47], v[24:27], v[112:127]
    ds_read_b128 v[36:39], v15
    ds_read_b64_tr_b16 v[64:65], v16 offset:3072
    ds_read_b64_tr_b16 v[66:67], v16 offset:3328
    ds_read_b64_tr_b16 v[68:69], v16 offset:7168
    ds_read_b64_tr_b16 v[70:71], v16 offset:7424
    s_waitcnt lgkmcnt(10)
    v_mfma_f32_32x32x16_bf16 v[96:111], v[48:51], v[28:31], v[96:111]
    v_mfma_f32_32x32x16_bf16 v[112:127], v[52:55], v[28:31], v[112:127]
    s_barrier
    v_add_u32 v12, s71, v8
    v_add_u32 v13, s71, v9
    v_add_u32 v14, s71, v10
    v_add_u32 v15, s71, v11
    v_add_u32 v16, s72, v4
    s_add_u32 s71, s71, 8192
    s_add_u32 s72, s72, 16384
    s_cmp_lt_u32 s72, 98304
    s_cselect_b32 s72, s72, 0
    ds_read_b128 v[24:27], v12
    ds_read_b64_tr_b16 v[40:41], v16 offset:0
    ds_read_b64_tr_b16 v[42:43], v16 offset:256
    ds_read_b64_tr_b16 v[44:45], v16 offset:4096
    ds_read_b64_tr_b16 v[46:47], v16 offset:4352
    s_waitcnt lgkmcnt(10)
    v_mfma_f32_32x32x16_bf16 v[96:111], v[56:59], v[32:35], v[96:111]
    v_mfma_f32_32x32x16_bf16 v[112:127], v[60:63], v[32:35], v[112:127]
    ds_read_b128 v[28:31], v13
    ds_read_b64_tr_b16 v[48:49], v16 offset:1024
    ds_read_b64_tr_b16 v[50:51], v16 offset:1280
    ds_read_b64_tr_b16 v[52:53], v16 offset:5120
    ds_read_b64_tr_b16 v[54:55], v16 offset:5376
    s_waitcnt lgkmcnt(10)
    v_mfma_f32_32x32x16_bf16 v[96:111], v[64:67], v[36:39], v[96:111]
    v_mfma_f32_32x32x16_bf16 v[112:127], v[68:71], v[36:39], v[112:127]
    s_add_u32 s73, s73, 1
    s_cmp_lt_u32 s73, 7
    s_cbranch_scc1 K1B_loop
    s_waitcnt lgkmcnt(0)
    s_nop 10
    v_mul_f32 v72, v96, v96
    v_mul_f32 v73, v97, v97
    v_mul_f32 v74, v98, v98
    v_mul_f32 v75, v99, v99
    v_mul_f32 v76, v100, v100
    v_mul_f32 v77, v101, v101
    v_mul_f32 v78, v102, v102
    v_mul_f32 v79, v103, v103
    v_mul_f32 v80, v104, v104
    v_mul_f32 v81, v105, v105
    v_mul_f32 v82, v106, v106
    v_mul_f32 v83, v107, v107
    v_mul_f32 v84, v108, v108
    v_mul_f32 v85, v109, v109
    v_mul_f32 v86, v110, v110
    v_mul_f32 v87, v111, v111
    v_fma_f32 v72, v72, s67, v7
    v_fma_f32 v73, v73, s67, v7
    v_fma_f32 v74, v74, s67, v7
    v_fma_f32 v75, v75, s67, v7
    v_fma_f32 v76, v76, s67, v7
    v_fma_f32 v77, v77, s67, v7
    v_fma_f32 v78, v78, s67, v7
    v_fma_f32 v79, v79, s67, v7
    v_fma_f32 v80, v80, s67, v7
    v_fma_f32 v81, v81, s67, v7
    v_fma_f32 v82, v82, s67, v7
    v_fma_f32 v83, v83, s67, v7
    v_fma_f32 v84, v84, s67, v7
    v_fma_f32 v85, v85, s67, v7
    v_fma_f32 v86, v86, s67, v7
    v_fma_f32 v87, v87, s67, v7
    v_mul_f32 v72, v72, v96
    v_mul_f32 v73, v73, v97
    v_mul_f32 v74, v74, v98
    v_mul_f32 v75, v75, v99
    v_mul_f32 v76, v76, v100
    v_mul_f32 v77, v77, v101
    v_mul_f32 v78, v78, v102
    v_mul_f32 v79, v79, v103
    v_mul_f32 v80, v80, v104
    v_mul_f32 v81, v81, v105
    v_mul_f32 v82, v82, v106
    v_mul_f32 v83, v83, v107
    v_mul_f32 v84, v84, v108
    v_mul_f32 v85, v85, v109
    v_mul_f32 v86, v86, v110
    v_mul_f32 v87, v87, v111
    v_exp_f32 v72, v72
    v_exp_f32 v73, v73
    v_exp_f32 v74, v74
    v_exp_f32 v75, v75
    v_exp_f32 v76, v76
    v_exp_f32 v77, v77
    v_exp_f32 v78, v78
    v_exp_f32 v79, v79
    v_exp_f32 v80, v80
    v_exp_f32 v81, v81
    v_exp_f32 v82, v82
    v_exp_f32 v83, v83
    v_exp_f32 v84, v84
    v_exp_f32 v85, v85
    v_exp_f32 v86, v86
    v_exp_f32 v87, v87
    v_add_f32 v72, 1.0, v72
    v_add_f32 v73, 1.0, v73
    v_add_f32 v74, 1.0, v74
    v_add_f32 v75, 1.0, v75
    v_add_f32 v76, 1.0, v76
    v_add_f32 v77, 1.0, v77
    v_add_f32 v78, 1.0, v78
    v_add_f32 v79, 1.0, v79
    v_add_f32 v80, 1.0, v80
    v_add_f32 v81, 1.0, v81
    v_add_f32 v82, 1.0, v82
    v_add_f32 v83, 1.0, v83
    v_add_f32 v84, 1.0, v84
    v_add_f32 v85, 1.0, v85
    v_add_f32 v86, 1.0, v86
    v_add_f32 v87, 1.0, v87
    v_rcp_f32 v72, v72
    v_rcp_f32 v73, v73
    v_rcp_f32 v74, v74
    v_rcp_f32 v75, v75
    v_rcp_f32 v76, v76
    v_rcp_f32 v77, v77
    v_rcp_f32 v78, v78
    v_rcp_f32 v79, v79
    v_rcp_f32 v80, v80
    v_rcp_f32 v81, v81
    v_rcp_f32 v82, v82
    v_rcp_f32 v83, v83
    v_rcp_f32 v84, v84
    v_rcp_f32 v85, v85
    v_rcp_f32 v86, v86
    v_rcp_f32 v87, v87
    v_mul_f32 v96, v96, v72
    v_mul_f32 v97, v97, v73
    v_mul_f32 v98, v98, v74
    v_mul_f32 v99, v99, v75
    v_mul_f32 v100, v100, v76
    v_mul_f32 v101, v101, v77
    v_mul_f32 v102, v102, v78
    v_mul_f32 v103, v103, v79
    v_mul_f32 v104, v104, v80
    v_mul_f32 v105, v105, v81
    v_mul_f32 v106, v106, v82
    v_mul_f32 v107, v107, v83
    v_mul_f32 v108, v108, v84
    v_mul_f32 v109, v109, v85
    v_mul_f32 v110, v110, v86
    v_mul_f32 v111, v111, v87
    v_cvt_pk_bf16_f32 v88, v96, v97
    v_cvt_pk_bf16_f32 v89, v98, v99
    v_cvt_pk_bf16_f32 v90, v100, v101
    v_cvt_pk_bf16_f32 v91, v102, v103
    v_cvt_pk_bf16_f32 v92, v104, v105
    v_cvt_pk_bf16_f32 v93, v106, v107
    v_cvt_pk_bf16_f32 v94, v108, v109
    v_cvt_pk_bf16_f32 v95, v110, v111
    buffer_store_dwordx4 v[88:91], v17, s[48:51], s68 offen offset:0 sc1
    buffer_store_dwordx4 v[92:95], v17, s[48:51], s68 offen offset:1024 sc1
    s_nop 1
    s_cmp_lt_u32 s70, 2
    s_cbranch_scc0 K1_w1_done
    v_mul_f32 v72, v112, v112
    v_mul_f32 v73, v113, v113
    v_mul_f32 v74, v114, v114
    v_mul_f32 v75, v115, v115
    v_mul_f32 v76, v116, v116
    v_mul_f32 v77, v117, v117
    v_mul_f32 v78, v118, v118
    v_mul_f32 v79, v119, v119
    v_mul_f32 v80, v120, v120
    v_mul_f32 v81, v121, v121
    v_mul_f32 v82, v122, v122
    v_mul_f32 v83, v123, v123
    v_mul_f32 v84, v124, v124
    v_mul_f32 v85, v125, v125
    v_mul_f32 v86, v126, v126
    v_mul_f32 v87, v127, v127
    v_fma_f32 v72, v72, s67, v7
    v_fma_f32 v73, v73, s67, v7
    v_fma_f32 v74, v74, s67, v7
    v_fma_f32 v75, v75, s67, v7
    v_fma_f32 v76, v76, s67, v7
    v_fma_f32 v77, v77, s67, v7
    v_fma_f32 v78, v78, s67, v7
    v_fma_f32 v79, v79, s67, v7
    v_fma_f32 v80, v80, s67, v7
    v_fma_f32 v81, v81, s67, v7
    v_fma_f32 v82, v82, s67, v7
    v_fma_f32 v83, v83, s67, v7
    v_fma_f32 v84, v84, s67, v7
    v_fma_f32 v85, v85, s67, v7
    v_fma_f32 v86, v86, s67, v7
    v_fma_f32 v87, v87, s67, v7
    v_mul_f32 v72, v72, v112
    v_mul_f32 v73, v73, v113
    v_mul_f32 v74, v74, v114
    v_mul_f32 v75, v75, v115
    v_mul_f32 v76, v76, v116
    v_mul_f32 v77, v77, v117
    v_mul_f32 v78, v78, v118
    v_mul_f32 v79, v79, v119
    v_mul_f32 v80, v80, v120
    v_mul_f32 v81, v81, v121
    v_mul_f32 v82, v82, v122
    v_mul_f32 v83, v83, v123
    v_mul_f32 v84, v84, v124
    v_mul_f32 v85, v85, v125
    v_mul_f32 v86, v86, v126
    v_mul_f32 v87, v87, v127
    v_exp_f32 v72, v72
    v_exp_f32 v73, v73
    v_exp_f32 v74, v74
    v_exp_f32 v75, v75
    v_exp_f32 v76, v76
    v_exp_f32 v77, v77
    v_exp_f32 v78, v78
    v_exp_f32 v79, v79
    v_exp_f32 v80, v80
    v_exp_f32 v81, v81
    v_exp_f32 v82, v82
    v_exp_f32 v83, v83
    v_exp_f32 v84, v84
    v_exp_f32 v85, v85
    v_exp_f32 v86, v86
    v_exp_f32 v87, v87
    v_add_f32 v72, 1.0, v72
    v_add_f32 v73, 1.0, v73
    v_add_f32 v74, 1.0, v74
    v_add_f32 v75, 1.0, v75
    v_add_f32 v76, 1.0, v76
    v_add_f32 v77, 1.0, v77
    v_add_f32 v78, 1.0, v78
    v_add_f32 v79, 1.0, v79
    v_add_f32 v80, 1.0, v80
    v_add_f32 v81, 1.0, v81
    v_add_f32 v82, 1.0, v82
    v_add_f32 v83, 1.0, v83
    v_add_f32 v84, 1.0, v84
    v_add_f32 v85, 1.0, v85
    v_add_f32 v86, 1.0, v86
    v_add_f32 v87, 1.0, v87
    v_rcp_f32 v72, v72
    v_rcp_f32 v73, v73
    v_rcp_f32 v74, v74
    v_rcp_f32 v75, v75
    v_rcp_f32 v76, v76
    v_rcp_f32 v77, v77
    v_rcp_f32 v78, v78
    v_rcp_f32 v79, v79
    v_rcp_f32 v80, v80
    v_rcp_f32 v81, v81
    v_rcp_f32 v82, v82
    v_rcp_f32 v83, v83
    v_rcp_f32 v84, v84
    v_rcp_f32 v85, v85
    v_rcp_f32 v86, v86
    v_rcp_f32 v87, v87
    v_mul_f32 v112, v112, v72
    v_mul_f32 v113, v113, v73
    v_mul_f32 v114, v114, v74
    v_mul_f32 v115, v115, v75
    v_mul_f32 v116, v116, v76
    v_mul_f32 v117, v117, v77
    v_mul_f32 v118, v118, v78
    v_mul_f32 v119, v119, v79
    v_mul_f32 v120, v120, v80
    v_mul_f32 v121, v121, v81
    v_mul_f32 v122, v122, v82
    v_mul_f32 v123, v123, v83
    v_mul_f32 v124, v124, v84
    v_mul_f32 v125, v125, v85
    v_mul_f32 v126, v126, v86
    v_mul_f32 v127, v127, v87
    v_cvt_pk_bf16_f32 v88, v112, v113
    v_cvt_pk_bf16_f32 v89, v114, v115
    v_cvt_pk_bf16_f32 v90, v116, v117
    v_cvt_pk_bf16_f32 v91, v118, v119
    v_cvt_pk_bf16_f32 v92, v120, v121
    v_cvt_pk_bf16_f32 v93, v122, v123
    v_cvt_pk_bf16_f32 v94, v124, v125
    v_cvt_pk_bf16_f32 v95, v126, v127
    buffer_store_dwordx4 v[88:91], v17, s[48:51], s68 offen offset:2048 sc1
    buffer_store_dwordx4 v[92:95], v17, s[48:51], s68 offen offset:3072 sc1
    s_nop 1
K1_w1_done:
    s_branch K12_mid
K1_qkv:
    s_lshl_b32 s65, s90, 2
    s_and_b32 s61, s92, 3
    s_add_u32 s65, s65, s61
    s_mul_i32 s93, s91, 6
    s_lshr_b32 s61, s92, 2
    s_add_u32 s93, s93, s61
    s_lshl_b32 s94, s93, 8
    s_lshl_b32 s61, s65, 2
    s_add_u32 s94, s94, s61
    s_add_u32 s94, s94, 24182784
    s_cmp_lt_u32 s60, 4
    s_cbranch_scc1 K1_qkv_comp
    s_mov_b32 s40, s16
    s_mov_b32 s41, s17
    s_mov_b32 s42, 1835008
    s_mov_b32 s43, 0x00020000
    s_mov_b32 s44, s18
    s_mov_b32 s45, s19
    s_mov_b32 s46, 1204224
    s_mov_b32 s47, 0x00020000
    s_sub_u32 s60, s60, 4
    s_lshr_b32 s66, s60, 2
    s_and_b32 s60, s60, 3
    s_mov_b32 s62, s93
    s_lshl_b32 s61, s65, 7
    s_lshl_b32 s63, s60, 5
    s_add_u32 s61, s61, s63
    s_lshl_b32 s63, s66, 4
    s_add_u32 s61, s61, s63
    s_lshl_b32 s63, s60, 12
    s_lshl_b32 s64, s66, 11
    s_add_u32 s63, s63, s64
    s_mul_i32 s64, s62, 224
    s_mul_i32 s62, s60, 56
    s_add_u32 s64, s64, s62
    s_mul_i32 s62, s66, 86016
    s_add_u32 s64, s64, s62
    v_lshrrev_b32 v17, 3, v1
    v_add_u32 v17, s61, v17
    v_mul_u32_u24 v17, 896, v17
    v_and_b32 v18, 7, v1
    v_lshrrev_b32 v19, 4, v1
    v_xor_b32 v18, v18, v19
    v_lshlrev_b32 v18, 4, v18
    v_add_u32 v5, v17, v18
    v_xor_b32 v18, 64, v18
    v_add_u32 v17, 7168, v17
    v_add_u32 v6, v17, v18
    v_lshrrev_b32 v17, 2, v1
    v_mul_u32_u24 v17, 2688, v17
    v_and_b32 v18, 3, v1
    v_lshlrev_b32 v18, 4, v18
    v_add_u32 v7, v17, v18
    s_add_u32 m0, s63, 0
    s_mov_b32 s61, 0
    buffer_load_dwordx4 v5, s[40:43], s61 offen lds
    s_add_u32 m0, s63, 16384
    s_add_u32 s61, s64, 0
    buffer_load_dwordx4 v7, s[44:47], s61 offen lds
    s_add_u32 m0, s63, 1024
    s_mov_b32 s61, 0
    buffer_load_dwordx4 v6, s[40:43], s61 offen lds
    s_add_u32 m0, s63, 17408
    s_add_u32 s61, s64, 43008
    buffer_load_dwordx4 v7, s[44:47], s61 offen lds
    s_add_u32 m0, s63, 32768
    s_mov_b32 s61, 128
    buffer_load_dwordx4 v5, s[40:43], s61 offen lds
    s_add_u32 m0, s63, 49152
    s_add_u32 s61, s64, 172032
    buffer_load_dwordx4 v7, s[44:47], s61 offen lds
    s_add_u32 m0, s63, 33792
    s_mov_b32 s61, 128
    buffer_load_dwordx4 v6, s[40:43], s61 offen lds
    s_add_u32 m0, s63, 50176
    s_add_u32 s61, s64, 215040
    buffer_load_dwordx4 v7, s[44:47], s61 offen lds
    s_add_u32 m0, s63, 65536
    s_mov_b32 s61, 256
    buffer_load_dwordx4 v5, s[40:43], s61 offen lds
    s_add_u32 m0, s63, 81920
    s_add_u32 s61, s64, 344064
    buffer_load_dwordx4 v7, s[44:47], s61 offen lds
    s_add_u32 m0, s63, 66560
    s_mov_b32 s61, 256
    buffer_load_dwordx4 v6, s[40:43], s61 offen lds
    s_add_u32 m0, s63, 82944
    s_add_u32 s61, s64, 387072
    buffer_load_dwordx4 v7, s[44:47], s61 offen lds
    s_waitcnt vmcnt(8)
    s_barrier
    s_add_u32 m0, s63, 98304
    s_mov_b32 s61, 384
    buffer_load_dwordx4 v5, s[40:43], s61 offen lds
    s_add_u32 m0, s63, 114688
    s_add_u32 s61, s64, 516096
    buffer_load_dwordx4 v7, s[44:47], s61 offen lds
    s_add_u32 m0, s63, 99328
    s_mov_b32 s61, 384
    buffer_load_dwordx4 v6, s[40:43], s61 offen lds
    s_add_u32 m0, s63, 115712
    s_add_u32 s61, s64, 559104
    buffer_load_dwordx4 v7, s[44:47], s61 offen lds
    s_waitcnt vmcnt(8)
    s_barrier
    s_add_u32 m0, s63, 0
    s_mov_b32 s61, 512
    buffer_load_dwordx4 v5, s[40:43], s61 offen lds
    s_add_u32 m0, s63, 16384
    s_add_u32 s61, s64, 688128
    buffer_load_dwordx4 v7, s[44:47], s61 offen lds
    s_add_u32 m0, s63, 1024
    s_mov_b32 s61, 512
    buffer_load_dwordx4 v6, s[40:43], s61 offen lds
    s_add_u32 m0, s63, 17408
    s_add_u32 s61, s64, 731136
    buffer_load_dwordx4 v7, s[44:47], s61 offen lds
    s_waitcnt vmcnt(8)
    s_barrier
    s_add_u32 m0, s63, 32768
    s_mov_b32 s61, 640
    buffer_load_dwordx4 v5, s[40:43], s61 offen lds
    s_add_u32 m0, s63, 49152
    s_add_u32 s61, s64, 860160
    buffer_load_dwordx4 v7, s[44:47], s61 offen lds
    s_add_u32 m0, s63, 33792
    s_mov_b32 s61, 640
    buffer_load_dwordx4 v6, s[40:43], s61 offen lds
    s_add_u32 m0, s63, 50176
    s_add_u32 s61, s64, 903168
    buffer_load_dwordx4 v7, s[44:47], s61 offen lds
    s_waitcnt vmcnt(8)
    s_barrier
    s_add_u32 m0, s63, 65536
    s_mov_b32 s61, 768
    buffer_load_dwordx4 v5, s[40:43], s61 offen lds
    s_add_u32 m0, s63, 81920
    s_add_u32 s61, s64, 1032192
    buffer_load_dwordx4 v7, s[44:47], s61 offen lds
    s_add_u32 m0, s63, 66560
    s_mov_b32 s61, 768
    buffer_load_dwordx4 v6, s[40:43], s61 offen lds
    s_add_u32 m0, s63, 82944
    s_add_u32 s61, s64, 1075200
    buffer_load_dwordx4 v7, s[44:47], s61 offen lds
    s_waitcnt vmcnt(8)
    s_barrier
    s_waitcnt vmcnt(4)
    s_barrier
    s_waitcnt vmcnt(0)
    s_barrier
    s_barrier
    s_branch K12_mid
K1_qkv_comp:
    s_mov_b32 s48, s38
    s_mov_b32 s49, s39
    s_mov_b32 s50, 33554432
    s_mov_b32 s51, 0x00020000
    s_cmp_eq_u32 s60, 0
    s_cbranch_scc0 K1_notok1
    s_mov_b32 s56, s36
    s_mov_b32 s57, s37
    s_mov_b32 s58, 256
    s_mov_b32 s59, 0x00020000
    s_or_b32 s88, s88, 1
    s_mov_b32 s85, 1
    v_mov_b32 v158, s88
    v_mov_b32 v159, 0
    v_mov_b32 v157, 0
    v_cmp_eq_u32 vcc, 0, v1
    s_and_saveexec_b64 s[86:87], vcc
    buffer_atomic_cmpswap v[158:159], v157, s[56:59], 0 offen sc0 sc1
    s_mov_b64 exec, s[86:87]
K1_notok1:
    s_lshl_b32 s61, s60, 12
    v_lshlrev_b32 v17, 7, v3
    v_add_u32 v17, s61, v17
    v_bfe_u32 v18, v3, 1, 3
    v_add_u32 v19, 0, v2
    v_xor_b32 v19, v19, v18
    v_lshlrev_b32 v19, 4, v19
    v_add_u32 v8, v17, v19
    v_add_u32 v19, 2, v2
    v_xor_b32 v19, v19, v18
    v_lshlrev_b32 v19, 4, v19
    v_add_u32 v9, v17, v19
    v_add_u32 v19, 4, v2
    v_xor_b32 v19, v19, v18
    v_lshlrev_b32 v19, 4, v19
    v_add_u32 v10, v17, v19
    v_add_u32 v19, 6, v2
    v_xor_b32 v19, v19, v18
    v_lshlrev_b32 v19, 4, v19
    v_add_u32 v11, v17, v19
    s_cmp_lt_u32 s93, 8
    s_cbranch_scc0 K1_v
    s_mov_b32 s66, 0
    s_mov_b32 s67, 0
    v_mov_b32 v60, 0
    v_mov_b32 v61, 0
    v_mov_b32 v62, 0
    v_mov_b32 v63, 0
    v_mov_b32 v64, 0
    v_mov_b32 v65, 0
    v_mov_b32 v66, 0
    v_mov_b32 v67, 0
    v_mov_b32 v68, 0
    v_mov_b32 v69, 0
    v_mov_b32 v70, 0
    v_mov_b32 v71, 0
    v_mov_b32 v72, 0
    v_mov_b32 v73, 0
    v_mov_b32 v74, 0
    v_mov_b32 v75, 0
    v_mov_b32 v76, 0
    v_mov_b32 v77, 0
    v_mov_b32 v78, 0
    v_mov_b32 v79, 0
    v_mov_b32 v80, 0
    v_mov_b32 v81, 0
    v_mov_b32 v82, 0
    v_mov_b32 v83, 0
    v_mov_b32 v84, 0
    v_mov_b32 v85, 0
    v_mov_b32 v86, 0
    v_mov_b32 v87, 0
    v_mov_b32 v88, 0
    v_mov_b32 v89, 0
    v_mov_b32 v90, 0
    v_mov_b32 v91, 0
    v_mov_b32 v92, 0
    v_mov_b32 v93, 0
    v_mov_b32 v94, 0
    v_mov_b32 v95, 0
    v_mov_b32 v96, 0
    v_mov_b32 v97, 0
    v_mov_b32 v98, 0
    v_mov_b32 v99, 0
    v_mov_b32 v100, 0
    v_mov_b32 v101, 0
    v_mov_b32 v102, 0
    v_mov_b32 v103, 0
    v_mov_b32 v104, 0
    v_mov_b32 v105, 0
    v_mov_b32 v106, 0
    v_mov_b32 v107, 0
    v_mov_b32 v108, 0
    v_mov_b32 v109, 0
    v_mov_b32 v110, 0
    v_mov_b32 v111, 0
    v_mov_b32 v112, 0
    v_mov_b32 v113, 0
    v_mov_b32 v114, 0
    v_mov_b32 v115, 0
    v_mov_b32 v116, 0
    v_mov_b32 v117, 0
    v_mov_b32 v118, 0
    v_mov_b32 v119, 0
    v_mov_b32 v120, 0
    v_mov_b32 v121, 0
    v_mov_b32 v122, 0
    v_mov_b32 v123, 0
    v_add_u32 v12, s66, v8
    v_add_u32 v13, s66, v9
    v_add_u32 v14, s66, v10
    v_add_u32 v15, s66, v11
    v_add_u32 v16, s66, v4
    s_add_u32 s66, s66, 32768
    s_and_b32 s66, s66, 131071
    s_barrier
    ds_read_b128 v[20:23], v12
    ds_read_b64_tr_b16 v[28:29], v16 offset:16384
    ds_read_b64_tr_b16 v[30:31], v16 offset:16640
    ds_read_b64_tr_b16 v[32:33], v16 offset:20480
    ds_read_b64_tr_b16 v[34:35], v16 offset:20736
    ds_read_b64_tr_b16 v[36:37], v16 offset:24576
    ds_read_b64_tr_b16 v[38:39], v16 offset:24832
    ds_read_b64_tr_b16 v[40:41], v16 offset:28672
    ds_read_b64_tr_b16 v[42:43], v16 offset:28928
.p2align 6
K1_qk_loop:
    ds_read_b128 v[24:27], v13
    ds_read_b64_tr_b16 v[44:45], v16 offset:17408
    ds_read_b64_tr_b16 v[46:47], v16 offset:17664
    ds_read_b64_tr_b16 v[48:49], v16 offset:21504
    ds_read_b64_tr_b16 v[50:51], v16 offset:21760
    ds_read_b64_tr_b16 v[52:53], v16 offset:25600
    ds_read_b64_tr_b16 v[54:55], v16 offset:25856
    ds_read_b64_tr_b16 v[56:57], v16 offset:29696
    ds_read_b64_tr_b16 v[58:59], v16 offset:29952
    s_waitcnt lgkmcnt(9)
    v_mfma_f32_32x32x16_bf16 v[60:75], v[28:31], v[20:23], v[60:75]
    v_mfma_f32_32x32x16_bf16 v[76:91], v[32:35], v[20:23], v[76:91]
    v_mfma_f32_32x32x16_bf16 v[92:107], v[36:39], v[20:23], v[92:107]
    v_mfma_f32_32x32x16_bf16 v[108:123], v[40:43], v[20:23], v[108:123]
    ds_read_b128 v[20:23], v14
    ds_read_b64_tr_b16 v[28:29], v16 offset:18432
    ds_read_b64_tr_b16 v[30:31], v16 offset:18688
    ds_read_b64_tr_b16 v[32:33], v16 offset:22528
    ds_read_b64_tr_b16 v[34:35], v16 offset:22784
    ds_read_b64_tr_b16 v[36:37], v16 offset:26624
    ds_read_b64_tr_b16 v[38:39], v16 offset:26880
    ds_read_b64_tr_b16 v[40:41], v16 offset:30720
    ds_read_b64_tr_b16 v[42:43], v16 offset:30976
    s_waitcnt lgkmcnt(9)
    v_mfma_f32_32x32x16_bf16 v[60:75], v[44:47], v[24:27], v[60:75]
    v_mfma_f32_32x32x16_bf16 v[76:91], v[48:51], v[24:27], v[76:91]
    v_mfma_f32_32x32x16_bf16 v[92:107], v[52:55], v[24:27], v[92:107]
    v_mfma_f32_32x32x16_bf16 v[108:123], v[56:59], v[24:27], v[108:123]
    ds_read_b128 v[24:27], v15
    ds_read_b64_tr_b16 v[44:45], v16 offset:19456
    ds_read_b64_tr_b16 v[46:47], v16 offset:19712
    ds_read_b64_tr_b16 v[48:49], v16 offset:23552
    ds_read_b64_tr_b16 v[50:51], v16 offset:23808
    ds_read_b64_tr_b16 v[52:53], v16 offset:27648
    ds_read_b64_tr_b16 v[54:55], v16 offset:27904
    ds_read_b64_tr_b16 v[56:57], v16 offset:31744
    ds_read_b64_tr_b16 v[58:59], v16 offset:32000
    s_waitcnt lgkmcnt(9)
    v_mfma_f32_32x32x16_bf16 v[60:75], v[28:31], v[20:23], v[60:75]
    v_mfma_f32_32x32x16_bf16 v[76:91], v[32:35], v[20:23], v[76:91]
    v_mfma_f32_32x32x16_bf16 v[92:107], v[36:39], v[20:23], v[92:107]
    v_mfma_f32_32x32x16_bf16 v[108:123], v[40:43], v[20:23], v[108:123]
    s_waitcnt lgkmcnt(0)
    s_barrier
    v_add_u32 v12, s66, v8
    v_add_u32 v13, s66, v9
    v_add_u32 v14, s66, v10
    v_add_u32 v15, s66, v11
    v_add_u32 v16, s66, v4
    s_add_u32 s66, s66, 32768
    s_and_b32 s66, s66, 131071
    ds_read_b128 v[20:23], v12
    ds_read_b64_tr_b16 v[28:29], v16 offset:16384
    ds_read_b64_tr_b16 v[30:31], v16 offset:16640
    ds_read_b64_tr_b16 v[32:33], v16 offset:20480
    ds_read_b64_tr_b16 v[34:35], v16 offset:20736
    ds_read_b64_tr_b16 v[36:37], v16 offset:24576
    ds_read_b64_tr_b16 v[38:39], v16 offset:24832
    ds_read_b64_tr_b16 v[40:41], v16 offset:28672
    ds_read_b64_tr_b16 v[42:43], v16 offset:28928
    v_mfma_f32_32x32x16_bf16 v[60:75], v[44:47], v[24:27], v[60:75]
    v_mfma_f32_32x32x16_bf16 v[76:91], v[48:51], v[24:27], v[76:91]
    v_mfma_f32_32x32x16_bf16 v[92:107], v[52:55], v[24:27], v[92:107]
    v_mfma_f32_32x32x16_bf16 v[108:123], v[56:59], v[24:27], v[108:123]
    s_add_u32 s67, s67, 1
    s_cmp_lt_u32 s67, 7
    s_cbranch_scc1 K1_qk_loop
    s_lshl_b32 s62, s93, 19
    s_lshl_b32 s61, s65, 2
    s_add_u32 s61, s61, s60
    s_lshl_b32 s61, s61, 11
    s_add_u32 s61, s61, s62
    v_lshlrev_b32 v17, 4, v1
    v_add_u32 v17, s61, v17
    s_cmp_lt_u32 s93, 4
    s_cselect_b32 s62, 1049335798, 1.0
    v_mov_b32 v18, 0x3f803f80
    v_mov_b32 v19, 0x00003f80
    v_cmp_lt_u32 vcc, 31, v1
    s_nop 4
    v_mul_f32 v60, s62, v60
    v_mul_f32 v61, s62, v61
    v_mul_f32 v62, s62, v62
    v_mul_f32 v63, s62, v63
    v_mul_f32 v64, s62, v64
    v_mul_f32 v65, s62, v65
    v_mul_f32 v66, s62, v66
    v_mul_f32 v67, s62, v67
    v_mul_f32 v68, s62, v68
    v_mul_f32 v69, s62, v69
    v_mul_f32 v70, s62, v70
    v_mul_f32 v71, s62, v71
    v_mul_f32 v72, s62, v72
    v_mul_f32 v73, s62, v73
    v_mul_f32 v74, s62, v74
    v_mul_f32 v75, s62, v75
    v_cvt_pk_bf16_f32 v124, v60, v61
    v_cvt_pk_bf16_f32 v125, v62, v63
    v_cvt_pk_bf16_f32 v126, v64, v65
    v_cvt_pk_bf16_f32 v127, v66, v67
    v_cvt_pk_bf16_f32 v128, v68, v69
    v_cvt_pk_bf16_f32 v129, v70, v71
    v_cvt_pk_bf16_f32 v130, v72, v73
    v_cvt_pk_bf16_f32 v131, v74, v75
    v_cndmask_b32 v130, v130, v18, vcc
    v_cndmask_b32 v131, v131, v19, vcc
    s_mov_b32 s61, 0
    buffer_store_dwordx4 v[124:127], v17, s[48:51], s61 offen sc1
    buffer_store_dwordx4 v[128:131], v17, s[48:51], s61 offen offset:1024 sc1
    v_mul_f32 v76, s62, v76
    v_mul_f32 v77, s62, v77
    v_mul_f32 v78, s62, v78
    v_mul_f32 v79, s62, v79
    v_mul_f32 v80, s62, v80
    v_mul_f32 v81, s62, v81
    v_mul_f32 v82, s62, v82
    v_mul_f32 v83, s62, v83
    v_mul_f32 v84, s62, v84
    v_mul_f32 v85, s62, v85
    v_mul_f32 v86, s62, v86
    v_mul_f32 v87, s62, v87
    v_mul_f32 v88, s62, v88
    v_mul_f32 v89, s62, v89
    v_mul_f32 v90, s62, v90
    v_mul_f32 v91, s62, v91
    v_cvt_pk_bf16_f32 v132, v76, v77
    v_cvt_pk_bf16_f32 v133, v78, v79
    v_cvt_pk_bf16_f32 v134, v80, v81
    v_cvt_pk_bf16_f32 v135, v82, v83
    v_cvt_pk_bf16_f32 v136, v84, v85
    v_cvt_pk_bf16_f32 v137, v86, v87
    v_cvt_pk_bf16_f32 v138, v88, v89
    v_cvt_pk_bf16_f32 v139, v90, v91
    v_cndmask_b32 v138, v138, v18, vcc
    v_cndmask_b32 v139, v139, v19, vcc
    s_mov_b32 s61, 131072
    buffer_store_dwordx4 v[132:135], v17, s[48:51], s61 offen sc1
    buffer_store_dwordx4 v[136:139], v17, s[48:51], s61 offen offset:1024 sc1
    v_mul_f32 v92, s62, v92
    v_mul_f32 v93, s62, v93
    v_mul_f32 v94, s62, v94
    v_mul_f32 v95, s62, v95
    v_mul_f32 v96, s62, v96
    v_mul_f32 v97, s62, v97
    v_mul_f32 v98, s62, v98
    v_mul_f32 v99, s62, v99
    v_mul_f32 v100, s62, v100
    v_mul_f32 v101, s62, v101
    v_mul_f32 v102, s62, v102
    v_mul_f32 v103, s62, v103
    v_mul_f32 v104, s62, v104
    v_mul_f32 v105, s62, v105
    v_mul_f32 v106, s62, v106
    v_mul_f32 v107, s62, v107
    v_cvt_pk_bf16_f32 v124, v92, v93
    v_cvt_pk_bf16_f32 v125, v94, v95
    v_cvt_pk_bf16_f32 v126, v96, v97
    v_cvt_pk_bf16_f32 v127, v98, v99
    v_cvt_pk_bf16_f32 v128, v100, v101
    v_cvt_pk_bf16_f32 v129, v102, v103
    v_cvt_pk_bf16_f32 v130, v104, v105
    v_cvt_pk_bf16_f32 v131, v106, v107
    v_cndmask_b32 v130, v130, v18, vcc
    v_cndmask_b32 v131, v131, v19, vcc
    s_mov_b32 s61, 262144
    buffer_store_dwordx4 v[124:127], v17, s[48:51], s61 offen sc1
    buffer_store_dwordx4 v[128:131], v17, s[48:51], s61 offen offset:1024 sc1
    v_mul_f32 v108, s62, v108
    v_mul_f32 v109, s62, v109
    v_mul_f32 v110, s62, v110
    v_mul_f32 v111, s62, v111
    v_mul_f32 v112, s62, v112
    v_mul_f32 v113, s62, v113
    v_mul_f32 v114, s62, v114
    v_mul_f32 v115, s62, v115
    v_mul_f32 v116, s62, v116
    v_mul_f32 v117, s62, v117
    v_mul_f32 v118, s62, v118
    v_mul_f32 v119, s62, v119
    v_mul_f32 v120, s62, v120
    v_mul_f32 v121, s62, v121
    v_mul_f32 v122, s62, v122
    v_mul_f32 v123, s62, v123
    v_cvt_pk_bf16_f32 v132, v108, v109
    v_cvt_pk_bf16_f32 v133, v110, v111
    v_cvt_pk_bf16_f32 v134, v112, v113
    v_cvt_pk_bf16_f32 v135, v114, v115
    v_cvt_pk_bf16_f32 v136, v116, v117
    v_cvt_pk_bf16_f32 v137, v118, v119
    v_cvt_pk_bf16_f32 v138, v120, v121
    v_cvt_pk_bf16_f32 v139, v122, v123
    v_cndmask_b32 v138, v138, v18, vcc
    v_cndmask_b32 v139, v139, v19, vcc
    s_mov_b32 s61, 393216
    buffer_store_dwordx4 v[132:135], v17, s[48:51], s61 offen sc1
    buffer_store_dwordx4 v[136:139], v17, s[48:51], s61 offen offset:1024 sc1
    s_branch K12_mid
K1_v:
    s_mov_b32 s66, 0
    s_mov_b32 s67, 0
    v_mov_b32 v60, 0
    v_mov_b32 v61, 0
    v_mov_b32 v62, 0
    v_mov_b32 v63, 0
    v_mov_b32 v64, 0
    v_mov_b32 v65, 0
    v_mov_b32 v66, 0
    v_mov_b32 v67, 0
    v_mov_b32 v68, 0
    v_mov_b32 v69, 0
    v_mov_b32 v70, 0
    v_mov_b32 v71, 0
    v_mov_b32 v72, 0
    v_mov_b32 v73, 0
    v_mov_b32 v74, 0
    v_mov_b32 v75, 0
    v_mov_b32 v76, 0
    v_mov_b32 v77, 0
    v_mov_b32 v78, 0
    v_mov_b32 v79, 0
    v_mov_b32 v80, 0
    v_mov_b32 v81, 0
    v_mov_b32 v82, 0
    v_mov_b32 v83, 0
    v_mov_b32 v84, 0
    v_mov_b32 v85, 0
    v_mov_b32 v86, 0
    v_mov_b32 v87, 0
    v_mov_b32 v88, 0
    v_mov_b32 v89, 0
    v_mov_b32 v90, 0
    v_mov_b32 v91, 0
    v_mov_b32 v92, 0
    v_mov_b32 v93, 0
    v_mov_b32 v94, 0
    v_mov_b32 v95, 0
    v_mov_b32 v96, 0
    v_mov_b32 v97, 0
    v_mov_b32 v98, 0
    v_mov_b32 v99, 0
    v_mov_b32 v100, 0
    v_mov_b32 v101, 0
    v_mov_b32 v102, 0
    v_mov_b32 v103, 0
    v_mov_b32 v104, 0
    v_mov_b32 v105, 0
    v_mov_b32 v106, 0
    v_mov_b32 v107, 0
    v_mov_b32 v108, 0
    v_mov_b32 v109, 0
    v_mov_b32 v110, 0
    v_mov_b32 v111, 0
    v_mov_b32 v112, 0
    v_mov_b32 v113, 0
    v_mov_b32 v114, 0
    v_mov_b32 v115, 0
    v_mov_b32 v116, 0
    v_mov_b32 v117, 0
    v_mov_b32 v118, 0
    v_mov_b32 v119, 0
    v_mov_b32 v120, 0
    v_mov_b32 v121, 0
    v_mov_b32 v122, 0
    v_mov_b32 v123, 0
    v_add_u32 v12, s66, v8
    v_add_u32 v13, s66, v9
    v_add_u32 v14, s66, v10
    v_add_u32 v15, s66, v11
    v_add_u32 v16, s66, v4
    s_add_u32 s66, s66, 32768
    s_and_b32 s66, s66, 131071
    s_barrier
    ds_read_b128 v[20:23], v12
    ds_read_b64_tr_b16 v[28:29], v16 offset:16384
    ds_read_b64_tr_b16 v[30:31], v16 offset:16640
    ds_read_b64_tr_b16 v[32:33], v16 offset:20480
    ds_read_b64_tr_b16 v[34:35], v16 offset:20736
    ds_read_b64_tr_b16 v[36:37], v16 offset:24576
    ds_read_b64_tr_b16 v[38:39], v16 offset:24832
    ds_read_b64_tr_b16 v[40:41], v16 offset:28672
    ds_read_b64_tr_b16 v[42:43], v16 offset:28928
.p2align 6
K1_v_loop:
    ds_read_b128 v[24:27], v13
    ds_read_b64_tr_b16 v[44:45], v16 offset:17408
    ds_read_b64_tr_b16 v[46:47], v16 offset:17664
    ds_read_b64_tr_b16 v[48:49], v16 offset:21504
    ds_read_b64_tr_b16 v[50:51], v16 offset:21760
    ds_read_b64_tr_b16 v[52:53], v16 offset:25600
    ds_read_b64_tr_b16 v[54:55], v16 offset:25856
    ds_read_b64_tr_b16 v[56:57], v16 offset:29696
    ds_read_b64_tr_b16 v[58:59], v16 offset:29952
    s_waitcnt lgkmcnt(9)
    v_mfma_f32_32x32x16_bf16 v[60:75], v[20:23], v[28:31], v[60:75]
    v_mfma_f32_32x32x16_bf16 v[76:91], v[20:23], v[32:35], v[76:91]
    v_mfma_f32_32x32x16_bf16 v[92:107], v[20:23], v[36:39], v[92:107]
    v_mfma_f32_32x32x16_bf16 v[108:123], v[20:23], v[40:43], v[108:123]
    ds_read_b128 v[20:23], v14
    ds_read_b64_tr_b16 v[28:29], v16 offset:18432
    ds_read_b64_tr_b16 v[30:31], v16 offset:18688
    ds_read_b64_tr_b16 v[32:33], v16 offset:22528
    ds_read_b64_tr_b16 v[34:35], v16 offset:22784
    ds_read_b64_tr_b16 v[36:37], v16 offset:26624
    ds_read_b64_tr_b16 v[38:39], v16 offset:26880
    ds_read_b64_tr_b16 v[40:41], v16 offset:30720
    ds_read_b64_tr_b16 v[42:43], v16 offset:30976
    s_waitcnt lgkmcnt(9)
    v_mfma_f32_32x32x16_bf16 v[60:75], v[24:27], v[44:47], v[60:75]
    v_mfma_f32_32x32x16_bf16 v[76:91], v[24:27], v[48:51], v[76:91]
    v_mfma_f32_32x32x16_bf16 v[92:107], v[24:27], v[52:55], v[92:107]
    v_mfma_f32_32x32x16_bf16 v[108:123], v[24:27], v[56:59], v[108:123]
    ds_read_b128 v[24:27], v15
    ds_read_b64_tr_b16 v[44:45], v16 offset:19456
    ds_read_b64_tr_b16 v[46:47], v16 offset:19712
    ds_read_b64_tr_b16 v[48:49], v16 offset:23552
    ds_read_b64_tr_b16 v[50:51], v16 offset:23808
    ds_read_b64_tr_b16 v[52:53], v16 offset:27648
    ds_read_b64_tr_b16 v[54:55], v16 offset:27904
    ds_read_b64_tr_b16 v[56:57], v16 offset:31744
    ds_read_b64_tr_b16 v[58:59], v16 offset:32000
    s_waitcnt lgkmcnt(9)
    v_mfma_f32_32x32x16_bf16 v[60:75], v[20:23], v[28:31], v[60:75]
    v_mfma_f32_32x32x16_bf16 v[76:91], v[20:23], v[32:35], v[76:91]
    v_mfma_f32_32x32x16_bf16 v[92:107], v[20:23], v[36:39], v[92:107]
    v_mfma_f32_32x32x16_bf16 v[108:123], v[20:23], v[40:43], v[108:123]
    s_waitcnt lgkmcnt(0)
    s_barrier
    v_add_u32 v12, s66, v8
    v_add_u32 v13, s66, v9
    v_add_u32 v14, s66, v10
    v_add_u32 v15, s66, v11
    v_add_u32 v16, s66, v4
    s_add_u32 s66, s66, 32768
    s_and_b32 s66, s66, 131071
    ds_read_b128 v[20:23], v12
    ds_read_b64_tr_b16 v[28:29], v16 offset:16384
    ds_read_b64_tr_b16 v[30:31], v16 offset:16640
    ds_read_b64_tr_b16 v[32:33], v16 offset:20480
    ds_read_b64_tr_b16 v[34:35], v16 offset:20736
    ds_read_b64_tr_b16 v[36:37], v16 offset:24576
    ds_read_b64_tr_b16 v[38:39], v16 offset:24832
    ds_read_b64_tr_b16 v[40:41], v16 offset:28672
    ds_read_b64_tr_b16 v[42:43], v16 offset:28928
    v_mfma_f32_32x32x16_bf16 v[60:75], v[24:27], v[44:47], v[60:75]
    v_mfma_f32_32x32x16_bf16 v[76:91], v[24:27], v[48:51], v[76:91]
    v_mfma_f32_32x32x16_bf16 v[92:107], v[24:27], v[52:55], v[92:107]
    v_mfma_f32_32x32x16_bf16 v[108:123], v[24:27], v[56:59], v[108:123]
    s_add_u32 s67, s67, 1
    s_cmp_lt_u32 s67, 7
    s_cbranch_scc1 K1_v_loop
    s_lshl_b32 s62, s93, 19
    s_lshl_b32 s61, s65, 2
    s_add_u32 s61, s61, s60
    s_lshl_b32 s61, s61, 11
    s_add_u32 s61, s61, s62
    v_lshlrev_b32 v17, 4, v1
    v_add_u32 v17, s61, v17
    v_mov_b32 v18, 0x3f803f80
    v_cmp_eq_u32 vcc, 28, v3
    s_nop 4
    v_cvt_pk_bf16_f32 v124, v60, v61
    v_cvt_pk_bf16_f32 v125, v62, v63
    v_cvt_pk_bf16_f32 v126, v64, v65
    v_cvt_pk_bf16_f32 v127, v66, v67
    v_cvt_pk_bf16_f32 v128, v68, v69
    v_cvt_pk_bf16_f32 v129, v70, v71
    v_cvt_pk_bf16_f32 v130, v72, v73
    v_cvt_pk_bf16_f32 v131, v74, v75
    v_cndmask_b32 v124, v124, v18, vcc
    v_cndmask_b32 v125, v125, v18, vcc
    v_cndmask_b32 v126, v126, v18, vcc
    v_cndmask_b32 v127, v127, v18, vcc
    v_cndmask_b32 v128, v128, v18, vcc
    v_cndmask_b32 v129, v129, v18, vcc
    v_cndmask_b32 v130, v130, v18, vcc
    v_cndmask_b32 v131, v131, v18, vcc
    s_mov_b32 s61, 0
    buffer_store_dwordx4 v[124:127], v17, s[48:51], s61 offen sc1
    buffer_store_dwordx4 v[128:131], v17, s[48:51], s61 offen offset:1024 sc1
    v_cvt_pk_bf16_f32 v132, v76, v77
    v_cvt_pk_bf16_f32 v133, v78, v79
    v_cvt_pk_bf16_f32 v134, v80, v81
    v_cvt_pk_bf16_f32 v135, v82, v83
    v_cvt_pk_bf16_f32 v136, v84, v85
    v_cvt_pk_bf16_f32 v137, v86, v87
    v_cvt_pk_bf16_f32 v138, v88, v89
    v_cvt_pk_bf16_f32 v139, v90, v91
    v_cndmask_b32 v132, v132, v18, vcc
    v_cndmask_b32 v133, v133, v18, vcc
    v_cndmask_b32 v134, v134, v18, vcc
    v_cndmask_b32 v135, v135, v18, vcc
    v_cndmask_b32 v136, v136, v18, vcc
    v_cndmask_b32 v137, v137, v18, vcc
    v_cndmask_b32 v138, v138, v18, vcc
    v_cndmask_b32 v139, v139, v18, vcc
    s_mov_b32 s61, 131072
    buffer_store_dwordx4 v[132:135], v17, s[48:51], s61 offen sc1
    buffer_store_dwordx4 v[136:139], v17, s[48:51], s61 offen offset:1024 sc1
    v_cvt_pk_bf16_f32 v124, v92, v93
    v_cvt_pk_bf16_f32 v125, v94, v95
    v_cvt_pk_bf16_f32 v126, v96, v97
    v_cvt_pk_bf16_f32 v127, v98, v99
    v_cvt_pk_bf16_f32 v128, v100, v101
    v_cvt_pk_bf16_f32 v129, v102, v103
    v_cvt_pk_bf16_f32 v130, v104, v105
    v_cvt_pk_bf16_f32 v131, v106, v107
    v_cndmask_b32 v124, v124, v18, vcc
    v_cndmask_b32 v125, v125, v18, vcc
    v_cndmask_b32 v126, v126, v18, vcc
    v_cndmask_b32 v127, v127, v18, vcc
    v_cndmask_b32 v128, v128, v18, vcc
    v_cndmask_b32 v129, v129, v18, vcc
    v_cndmask_b32 v130, v130, v18, vcc
    v_cndmask_b32 v131, v131, v18, vcc
    s_mov_b32 s61, 262144
    buffer_store_dwordx4 v[124:127], v17, s[48:51], s61 offen sc1
    buffer_store_dwordx4 v[128:131], v17, s[48:51], s61 offen offset:1024 sc1
    v_cvt_pk_bf16_f32 v132, v108, v109
    v_cvt_pk_bf16_f32 v133, v110, v111
    v_cvt_pk_bf16_f32 v134, v112, v113
    v_cvt_pk_bf16_f32 v135, v114, v115
    v_cvt_pk_bf16_f32 v136, v116, v117
    v_cvt_pk_bf16_f32 v137, v118, v119
    v_cvt_pk_bf16_f32 v138, v120, v121
    v_cvt_pk_bf16_f32 v139, v122, v123
    v_cndmask_b32 v132, v132, v18, vcc
    v_cndmask_b32 v133, v133, v18, vcc
    v_cndmask_b32 v134, v134, v18, vcc
    v_cndmask_b32 v135, v135, v18, vcc
    v_cndmask_b32 v136, v136, v18, vcc
    v_cndmask_b32 v137, v137, v18, vcc
    v_cndmask_b32 v138, v138, v18, vcc
    v_cndmask_b32 v139, v139, v18, vcc
    s_mov_b32 s61, 393216
    buffer_store_dwordx4 v[132:135], v17, s[48:51], s61 offen sc1
    buffer_store_dwordx4 v[136:139], v17, s[48:51], s61 offen offset:1024 sc1
    s_branch K12_mid
K12_mid:
    v_and_b32 v1, 63, v0
    v_lshrrev_b32 v2, 5, v1
    v_and_b32 v3, 31, v1
    v_bfe_u32 v8, v1, 2, 2
    v_mul_u32_u24 v9, 4, v2
    v_add_u32 v8, v8, v9
    v_lshlrev_b32 v16, 6, v8
    v_bfe_u32 v8, v1, 4, 1
    v_lshlrev_b32 v8, 5, v8
    v_and_b32 v9, 3, v1
    v_lshlrev_b32 v9, 3, v9
    v_add3_u32 v16, v16, v8, v9
    v_lshrrev_b32 v8, 6, v0
    v_lshlrev_b32 v4, 4, v1
    v_readfirstlane_b32 s60, v8
    s_and_b32 s68, s2, 7
    s_lshl_b32 s68, s68, 1
    s_bfe_u32 s61, s2, 0x10003
    s_add_u32 s68, s68, s61
    s_lshr_b32 s69, s2, 4
    s_mov_b32 s48, s38
    s_mov_b32 s49, s39
    s_mov_b32 s50, 33554432
    s_mov_b32 s51, 0x00020000
    s_waitcnt vmcnt(0) lgkmcnt(0)
    s_cmp_eq_u32 s85, 1
    s_cbranch_scc0 K12_t1
    v_readfirstlane_b32 s95, v158
    s_cmp_eq_u32 s95, 0
    s_cselect_b32 s95, s88, s95
    v_mov_b32 v8, 155648
    v_mov_b32 v9, s95
    ds_write_b32 v8, v9
    s_waitcnt lgkmcnt(0)
K12_t1:
    s_barrier
    s_cmp_eq_u32 s60, 8
    s_cbranch_scc0 K12_t2
    v_mov_b32 v8, 155648
    ds_read_b32 v9, v8
    s_waitcnt lgkmcnt(0)
    v_readfirstlane_b32 s95, v9
    v_mov_b32 v8, 0
    v_cmp_eq_u32 vcc, 0, v1
    s_and_saveexec_b64 s[86:87], vcc
    buffer_store_dword v9, v8, s[48:51], s94 offen sc1
    s_mov_b64 exec, s[86:87]
    s_lshr_b32 s61, s68, 2
    v_lshrrev_b32 v8, 4, v1
    v_lshl_add_u32 v8, v8, 2, s61
    v_mov_b32 v10, 8
    v_cmp_lt_u32 vcc, 47, v1
    s_nop 1
    v_cndmask_b32 v8, v8, v10, vcc
    v_lshlrev_b32 v8, 8, v8
    v_and_b32 v10, 15, v1
    v_lshl_add_u32 v8, v10, 2, v8
    s_mov_b32 s61, 24182784
    s_mov_b32 s62, 0
K12_poll:
    buffer_load_dword v10, v8, s[48:51], s61 offen sc1
    s_waitcnt vmcnt(0)
    v_cmp_ne_u32 vcc, s95, v10
    s_cbranch_vccz K12_t2
    s_sleep 4
    s_add_u32 s62, s62, 1
    s_cmp_lt_u32 s62, 0x80000
    s_cbranch_scc1 K12_poll
K12_t2:
    s_barrier
    v_mov_b32 v8, 155648
    ds_read_b32 v9, v8
    s_waitcnt lgkmcnt(0)
    v_readfirstlane_b32 s95, v9
    s_mov_b32 s84, 0
    s_cmp_lt_u32 s60, 8
    s_cbranch_scc1 K2_comp
    s_sub_u32 s64, s60, 8
    s_mov_b32 s71, 0
    s_cmp_ge_u32 s2, 224
    s_cselect_b32 s71, 1, s71
    s_cmp_ge_u32 s2, 252
    s_cselect_b32 s71, 2, s71
    s_lshl_b32 s63, s68, 17
    s_lshl_b32 s61, s64, 15
    s_add_u32 s63, s63, s61
    s_add_u32 s63, s63, 2097152
    s_lshl_b32 s75, s64, 12
    s_mov_b32 s80, s63
    s_mov_b32 s81, 0
K2_ld_top:
    s_mov_b32 s70, 0
    s_add_u32 m0, s70, s75
    s_add_u32 s61, s63, 2097152
    buffer_load_dwordx4 v4, s[48:51], s63 offen sc1 lds
    buffer_load_dwordx4 v4, s[48:51], s63 offen offset:1024 sc1 lds
    s_add_u32 m0, m0, 2048
    s_add_u32 s63, s63, 2048
    buffer_load_dwordx4 v4, s[48:51], s61 offen sc1 lds
    buffer_load_dwordx4 v4, s[48:51], s61 offen offset:1024 sc1 lds
    s_add_u32 s70, s70, 16384
    s_and_b32 s70, s70, 0xffff
    s_add_u32 m0, s70, s75
    s_add_u32 s61, s63, 2097152
    buffer_load_dwordx4 v4, s[48:51], s63 offen sc1 lds
    buffer_load_dwordx4 v4, s[48:51], s63 offen offset:1024 sc1 lds
    s_add_u32 m0, m0, 2048
    s_add_u32 s63, s63, 2048
    buffer_load_dwordx4 v4, s[48:51], s61 offen sc1 lds
    buffer_load_dwordx4 v4, s[48:51], s61 offen offset:1024 sc1 lds
    s_add_u32 s70, s70, 16384
    s_and_b32 s70, s70, 0xffff
    s_add_u32 m0, s70, s75
    s_add_u32 s61, s63, 2097152
    buffer_load_dwordx4 v4, s[48:51], s63 offen sc1 lds
    buffer_load_dwordx4 v4, s[48:51], s63 offen offset:1024 sc1 lds
    s_add_u32 m0, m0, 2048
    s_add_u32 s63, s63, 2048
    buffer_load_dwordx4 v4, s[48:51], s61 offen sc1 lds
    buffer_load_dwordx4 v4, s[48:51], s61 offen offset:1024 sc1 lds
    s_add_u32 s70, s70, 16384
    s_and_b32 s70, s70, 0xffff
    s_cmp_lt_u32 s71, 2
    s_cbranch_scc1 K2_ldw
    s_waitcnt vmcnt(8)
    s_barrier
    s_mov_b32 s66, 0
K2_ld_loop:
    s_waitcnt vmcnt(4)
    s_barrier
    s_add_u32 m0, s70, s75
    s_add_u32 s61, s63, 2097152
    buffer_load_dwordx4 v4, s[48:51], s63 offen sc1 lds
    buffer_load_dwordx4 v4, s[48:51], s63 offen offset:1024 sc1 lds
    s_add_u32 m0, m0, 2048
    s_add_u32 s63, s63, 2048
    buffer_load_dwordx4 v4, s[48:51], s61 offen sc1 lds
    buffer_load_dwordx4 v4, s[48:51], s61 offen offset:1024 sc1 lds
    s_add_u32 s70, s70, 16384
    s_and_b32 s70, s70, 0xffff
    s_add_u32 s66, s66, 1
    s_cmp_lt_u32 s66, 13
    s_cbranch_scc1 K2_ld_loop
K2_ld_tail:
    s_waitcnt vmcnt(4)
    s_barrier
    s_waitcnt vmcnt(0)
K2_ld_tail2:
    s_barrier
    s_cmp_eq_u32 s84, 0
    s_cbranch_scc1 K2_nosidepub
    s_waitcnt vmcnt(0)
    v_mov_b32 v8, 0
    v_mov_b32 v9, s95
    v_cmp_eq_u32 vcc, 0, v1
    s_and_saveexec_b64 s[86:87], vcc
    buffer_store_dword v9, v8, s[48:51], s84 offen sc1
    s_mov_b64 exec, s[86:87]
    s_mov_b32 s84, 0
K2_nosidepub:
    s_barrier
    s_barrier
    v_mov_b32 v8, 122880
    ds_read_b32 v9, v8
    s_waitcnt lgkmcnt(0)
    v_readfirstlane_b32 s61, v9
    s_cmp_lg_u32 s81, 0
    s_cbranch_scc1 K2_ld_fin
    s_cmp_eq_u32 s61, 0
    s_cbranch_scc1 K2_ld_fin
    s_mov_b32 s81, 1
    s_mov_b32 s71, 2
    s_mov_b32 s63, s80
    s_branch K2_ld_top
K2_ld_fin:
    s_barrier
    s_barrier
    s_branch K23_mid
K2_ldw:
    s_lshr_b32 s73, s64, 1
    s_and_b32 s74, s64, 1
    v_lshrrev_b32 v8, 2, v1
    v_and_b32 v9, 3, v1
    v_lshlrev_b32 v9, 4, v9
    s_mul_i32 s61, s73, 28672
    s_add_u32 s61, s61, 65536
    v_add_u32 v16, s61, v16
    s_lshl_b32 s62, s74, 10
    s_add_u32 s66, s61, s62
    s_and_b32 s72, s2, 31
    s_lshl_b32 s72, s72, 1
    s_add_u32 s72, s72, s74
    s_mov_b32 s52, s16
    s_mov_b32 s53, s17
    s_mov_b32 s54, 1835008
    s_mov_b32 s55, 0x00020000
    s_lshl_b32 s61, s72, 5
    v_add_u32 v11, s61, v3
    s_cmp_eq_u32 s71, 1
    s_cbranch_scc1 K2_ld_w3
    s_mov_b32 s44, s26
    s_mov_b32 s45, s27
    s_mov_b32 s46, 401408
    s_mov_b32 s47, 0x00020000
    s_add_u32 s40, s38, 6291456
    s_addc_u32 s41, s39, 0
    s_mov_b32 s42, 1835008
    s_mov_b32 s43, 0x00020000
    v_mul_u32_u24 v8, 896, v8
    v_add_u32 v30, v8, v9
    s_lshr_b32 s57, s2, 5
    s_lshl_b32 s57, s57, 7
    s_mov_b32 s56, 14336
    v_subrev_u32 v9, 1, v11
    v_lshrrev_b32 v10, 5, v9
    v_mul_u32_u24 v10, 28672, v10
    v_and_b32 v18, 31, v9
    v_lshl_add_u32 v18, v2, 5, v18
    v_lshl_add_u32 v18, v18, 4, v10
    v_cmp_gt_u32 vcc, 2048, v9
    v_mov_b32 v10, 0x80000000
    s_nop 0
    v_cndmask_b32 v18, v10, v18, vcc
    v_add_u32 v9, 1, v11
    v_lshrrev_b32 v10, 5, v9
    v_mul_u32_u24 v10, 28672, v10
    v_and_b32 v19, 31, v9
    v_lshl_add_u32 v19, v2, 5, v19
    v_lshl_add_u32 v19, v19, 4, v10
    v_cmp_gt_u32 vcc, 2048, v9
    v_mov_b32 v10, 0x80000000
    s_nop 0
    v_cndmask_b32 v19, v10, v19, vcc
    v_subrev_u32 v9, 2, v11
    v_lshrrev_b32 v10, 5, v9
    v_mul_u32_u24 v10, 28672, v10
    v_and_b32 v20, 31, v9
    v_lshl_add_u32 v20, v2, 5, v20
    v_lshl_add_u32 v20, v20, 4, v10
    v_cmp_gt_u32 vcc, 2048, v9
    v_mov_b32 v10, 0x80000000
    s_nop 0
    v_cndmask_b32 v20, v10, v20, vcc
    v_add_u32 v9, 2, v11
    v_lshrrev_b32 v10, 5, v9
    v_mul_u32_u24 v10, 28672, v10
    v_and_b32 v21, 31, v9
    v_lshl_add_u32 v21, v2, 5, v21
    v_lshl_add_u32 v21, v21, 4, v10
    v_cmp_gt_u32 vcc, 2048, v9
    v_mov_b32 v10, 0x80000000
    s_nop 0
    v_cndmask_b32 v21, v10, v21, vcc
    s_branch K2_ld_w
K2_ld_w3:
    s_mov_b32 s44, s28
    s_mov_b32 s45, s29
    s_mov_b32 s46, 1605632
    s_mov_b32 s47, 0x00020000
    s_add_u32 s40, s38, 4194752
    s_addc_u32 s41, s39, 0
    s_mov_b32 s42, 65536
    s_mov_b32 s43, 0x00020000
    v_mul_u32_u24 v8, 3584, v8
    v_add_u32 v30, v8, v9
    s_sub_u32 s57, s2, 224
    s_lshl_b32 s57, s57, 7
    s_mov_b32 s56, 57344
    v_mov_b32 v18, 0
    v_mov_b32 v19, 0
    v_mov_b32 v20, 0
    v_mov_b32 v21, 0
K2_ld_w:
    s_lshl_b32 s61, s73, 6
    s_add_u32 s57, s57, s61
    s_mul_i32 s61, s56, s74
    s_add_u32 s57, s57, s61
    s_lshl_b32 s56, s56, 1
    v_mul_u32_u24 v11, 896, v11
    v_lshl_add_u32 v11, v2, 3, v11
    s_waitcnt vmcnt(8)
    s_barrier
    s_waitcnt vmcnt(4)
    s_barrier
    s_add_u32 m0, s70, s75
    s_add_u32 s61, s63, 2097152
    buffer_load_dwordx4 v4, s[48:51], s63 offen sc1 lds
    buffer_load_dwordx4 v4, s[48:51], s63 offen offset:1024 sc1 lds
    s_add_u32 m0, m0, 2048
    s_add_u32 s63, s63, 2048
    buffer_load_dwordx4 v4, s[48:51], s61 offen sc1 lds
    buffer_load_dwordx4 v4, s[48:51], s61 offen offset:1024 sc1 lds
    s_add_u32 s70, s70, 16384
    s_and_b32 s70, s70, 0xffff
    s_add_u32 m0, s66, 0
    s_nop 0
    buffer_load_dwordx4 v30, s[44:47], s57 offen lds
    s_add_u32 s57, s57, s56
    s_add_u32 m0, s66, 2048
    s_nop 0
    buffer_load_dwordx4 v30, s[44:47], s57 offen lds
    s_add_u32 s57, s57, s56
    s_add_u32 m0, s66, 4096
    s_nop 0
    buffer_load_dwordx4 v30, s[44:47], s57 offen lds
    s_add_u32 s57, s57, s56
    s_add_u32 m0, s66, 6144
    s_nop 0
    buffer_load_dwordx4 v30, s[44:47], s57 offen lds
    s_add_u32 s57, s57, s56
    s_add_u32 m0, s66, 8192
    s_nop 0
    buffer_load_dwordx4 v30, s[44:47], s57 offen lds
    s_add_u32 s57, s57, s56
    s_add_u32 m0, s66, 10240
    s_nop 0
    buffer_load_dwordx4 v30, s[44:47], s57 offen lds
    s_add_u32 s57, s57, s56
    s_add_u32 m0, s66, 12288
    s_nop 0
    buffer_load_dwordx4 v30, s[44:47], s57 offen lds
    s_add_u32 s57, s57, s56
    s_waitcnt vmcnt(11)
    s_barrier
    s_add_u32 m0, s70, s75
    s_add_u32 s61, s63, 2097152
    buffer_load_dwordx4 v4, s[48:51], s63 offen sc1 lds
    buffer_load_dwordx4 v4, s[48:51], s63 offen offset:1024 sc1 lds
    s_add_u32 m0, m0, 2048
    s_add_u32 s63, s63, 2048
    buffer_load_dwordx4 v4, s[48:51], s61 offen sc1 lds
    buffer_load_dwordx4 v4, s[48:51], s61 offen offset:1024 sc1 lds
    s_add_u32 s70, s70, 16384
    s_and_b32 s70, s70, 0xffff
    s_add_u32 m0, s66, 14336
    s_nop 0
    buffer_load_dwordx4 v30, s[44:47], s57 offen lds
    s_add_u32 s57, s57, s56
    s_add_u32 m0, s66, 16384
    s_nop 0
    buffer_load_dwordx4 v30, s[44:47], s57 offen lds
    s_add_u32 s57, s57, s56
    s_add_u32 m0, s66, 18432
    s_nop 0
    buffer_load_dwordx4 v30, s[44:47], s57 offen lds
    s_add_u32 s57, s57, s56
    s_add_u32 m0, s66, 20480
    s_nop 0
    buffer_load_dwordx4 v30, s[44:47], s57 offen lds
    s_add_u32 s57, s57, s56
    s_add_u32 m0, s66, 22528
    s_nop 0
    buffer_load_dwordx4 v30, s[44:47], s57 offen lds
    s_add_u32 s57, s57, s56
    s_add_u32 m0, s66, 24576
    s_nop 0
    buffer_load_dwordx4 v30, s[44:47], s57 offen lds
    s_add_u32 s57, s57, s56
    s_add_u32 m0, s66, 26624
    s_nop 0
    buffer_load_dwordx4 v30, s[44:47], s57 offen lds
    s_add_u32 s57, s57, s56
    s_waitcnt vmcnt(18)
    s_barrier
    s_add_u32 m0, s70, s75
    s_add_u32 s61, s63, 2097152
    buffer_load_dwordx4 v4, s[48:51], s63 offen sc1 lds
    buffer_load_dwordx4 v4, s[48:51], s63 offen offset:1024 sc1 lds
    s_add_u32 m0, m0, 2048
    s_add_u32 s63, s63, 2048
    buffer_load_dwordx4 v4, s[48:51], s61 offen sc1 lds
    buffer_load_dwordx4 v4, s[48:51], s61 offen offset:1024 sc1 lds
    s_add_u32 s70, s70, 16384
    s_and_b32 s70, s70, 0xffff
    s_and_b32 s61, s2, 31
    v_and_b32 v8, 7, v1
    v_min_u32 v8, 5, v8
    v_lshrrev_b32 v9, 1, v8
    v_add_u32 v9, s61, v9
    v_max_u32 v9, 1, v9
    v_min_u32 v9, 32, v9
    v_subrev_u32 v9, 1, v9
    v_and_b32 v8, 1, v8
    v_lshlrev_b32 v8, 2, v8
    v_lshl_add_u32 v8, v9, 3, v8
    s_mov_b32 s61, 24186880
    s_mov_b32 s62, 0
K12_pollh:
    buffer_load_dword v10, v8, s[48:51], s61 offen sc1
    s_waitcnt vmcnt(0)
    v_cmp_ne_u32 vcc, s95, v10
    s_cbranch_vccz K12_hok
    s_sleep 4
    s_add_u32 s62, s62, 1
    s_cmp_lt_u32 s62, 0x80000
    s_cbranch_scc1 K12_pollh
K12_hok:
    s_mov_b32 s61, 0
    buffer_load_dwordx4 v[64:67], v18, s[40:43], s61 offen sc1
    s_mov_b32 s61, 1024
    buffer_load_dwordx4 v[68:71], v18, s[40:43], s61 offen sc1
    s_mov_b32 s61, 2048
    buffer_load_dwordx4 v[72:75], v18, s[40:43], s61 offen sc1
    s_mov_b32 s61, 3072
    buffer_load_dwordx4 v[76:79], v18, s[40:43], s61 offen sc1
    s_mov_b32 s61, 4096
    buffer_load_dwordx4 v[80:83], v18, s[40:43], s61 offen sc1
    s_mov_b32 s61, 5120
    buffer_load_dwordx4 v[84:87], v18, s[40:43], s61 offen sc1
    s_mov_b32 s61, 6144
    buffer_load_dwordx4 v[88:91], v18, s[40:43], s61 offen sc1
    s_waitcnt vmcnt(18)
    s_barrier
    s_add_u32 m0, s70, s75
    s_add_u32 s61, s63, 2097152
    buffer_load_dwordx4 v4, s[48:51], s63 offen sc1 lds
    buffer_load_dwordx4 v4, s[48:51], s63 offen offset:1024 sc1 lds
    s_add_u32 m0, m0, 2048
    s_add_u32 s63, s63, 2048
    buffer_load_dwordx4 v4, s[48:51], s61 offen sc1 lds
    buffer_load_dwordx4 v4, s[48:51], s61 offen offset:1024 sc1 lds
    s_add_u32 s70, s70, 16384
    s_and_b32 s70, s70, 0xffff
    s_mov_b32 s61, 7168
    buffer_load_dwordx4 v[92:95], v19, s[40:43], s61 offen sc1
    s_mov_b32 s61, 8192
    buffer_load_dwordx4 v[96:99], v19, s[40:43], s61 offen sc1
    s_mov_b32 s61, 9216
    buffer_load_dwordx4 v[100:103], v19, s[40:43], s61 offen sc1
    s_mov_b32 s61, 10240
    buffer_load_dwordx4 v[104:107], v19, s[40:43], s61 offen sc1
    s_mov_b32 s61, 11264
    buffer_load_dwordx4 v[108:111], v19, s[40:43], s61 offen sc1
    s_mov_b32 s61, 12288
    buffer_load_dwordx4 v[112:115], v19, s[40:43], s61 offen sc1
    s_mov_b32 s61, 13312
    buffer_load_dwordx4 v[116:119], v19, s[40:43], s61 offen sc1
    s_waitcnt vmcnt(18)
    s_barrier
    s_add_u32 m0, s70, s75
    s_add_u32 s61, s63, 2097152
    buffer_load_dwordx4 v4, s[48:51], s63 offen sc1 lds
    buffer_load_dwordx4 v4, s[48:51], s63 offen offset:1024 sc1 lds
    s_add_u32 m0, m0, 2048
    s_add_u32 s63, s63, 2048
    buffer_load_dwordx4 v4, s[48:51], s61 offen sc1 lds
    buffer_load_dwordx4 v4, s[48:51], s61 offen offset:1024 sc1 lds
    s_add_u32 s70, s70, 16384
    s_and_b32 s70, s70, 0xffff
    s_lshr_b32 s61, s2, 5
    s_lshl_b32 s61, s61, 7
    s_lshl_b32 s62, s73, 6
    s_add_u32 s61, s61, s62
    buffer_load_dwordx2 v[22:23], v11, s[52:55], s61 offen offset:0
    buffer_load_dwordx2 v[24:25], v11, s[52:55], s61 offen offset:16
    buffer_load_dwordx2 v[26:27], v11, s[52:55], s61 offen offset:32
    buffer_load_dwordx2 v[28:29], v11, s[52:55], s61 offen offset:48
    s_waitcnt vmcnt(15)
    s_barrier
    s_add_u32 m0, s70, s75
    s_add_u32 s61, s63, 2097152
    buffer_load_dwordx4 v4, s[48:51], s63 offen sc1 lds
    buffer_load_dwordx4 v4, s[48:51], s63 offen offset:1024 sc1 lds
    s_add_u32 m0, m0, 2048
    s_add_u32 s63, s63, 2048
    buffer_load_dwordx4 v4, s[48:51], s61 offen sc1 lds
    buffer_load_dwordx4 v4, s[48:51], s61 offen offset:1024 sc1 lds
    s_add_u32 s70, s70, 16384
    s_and_b32 s70, s70, 0xffff
    s_waitcnt vmcnt(12)
    ds_read_b64_tr_b16 v[32:33], v16 offset:0
    ds_read_b64_tr_b16 v[34:35], v16 offset:512
    ds_read_b64_tr_b16 v[36:37], v16 offset:1024
    ds_read_b64_tr_b16 v[38:39], v16 offset:1536
    ds_read_b64_tr_b16 v[40:41], v16 offset:2048
    ds_read_b64_tr_b16 v[42:43], v16 offset:2560
    ds_read_b64_tr_b16 v[44:45], v16 offset:3072
    ds_read_b64_tr_b16 v[46:47], v16 offset:3584
    s_waitcnt lgkmcnt(6)
    v_mfma_f32_32x32x16_bf16 v[48:63], v[32:35], v[64:67], 0
    s_waitcnt lgkmcnt(4)
    v_mfma_f32_32x32x16_bf16 v[48:63], v[36:39], v[68:71], v[48:63]
    s_waitcnt lgkmcnt(2)
    v_mfma_f32_32x32x16_bf16 v[48:63], v[40:43], v[72:75], v[48:63]
    s_waitcnt lgkmcnt(0)
    v_mfma_f32_32x32x16_bf16 v[48:63], v[44:47], v[76:79], v[48:63]
    ds_read_b64_tr_b16 v[32:33], v16 offset:4096
    ds_read_b64_tr_b16 v[34:35], v16 offset:4608
    ds_read_b64_tr_b16 v[36:37], v16 offset:5120
    ds_read_b64_tr_b16 v[38:39], v16 offset:5632
    ds_read_b64_tr_b16 v[40:41], v16 offset:6144
    ds_read_b64_tr_b16 v[42:43], v16 offset:6656
    s_waitcnt lgkmcnt(4)
    v_mfma_f32_32x32x16_bf16 v[48:63], v[32:35], v[80:83], v[48:63]
    s_waitcnt lgkmcnt(2)
    v_mfma_f32_32x32x16_bf16 v[48:63], v[36:39], v[84:87], v[48:63]
    s_waitcnt lgkmcnt(0)
    v_mfma_f32_32x32x16_bf16 v[48:63], v[40:43], v[88:91], v[48:63]
    s_waitcnt vmcnt(8)
    s_barrier
    s_add_u32 m0, s70, s75
    s_add_u32 s61, s63, 2097152
    buffer_load_dwordx4 v4, s[48:51], s63 offen sc1 lds
    buffer_load_dwordx4 v4, s[48:51], s63 offen offset:1024 sc1 lds
    s_add_u32 m0, m0, 2048
    s_add_u32 s63, s63, 2048
    buffer_load_dwordx4 v4, s[48:51], s61 offen sc1 lds
    buffer_load_dwordx4 v4, s[48:51], s61 offen offset:1024 sc1 lds
    s_add_u32 s70, s70, 16384
    s_and_b32 s70, s70, 0xffff
    ds_read_b64_tr_b16 v[44:45], v16 offset:7168
    ds_read_b64_tr_b16 v[46:47], v16 offset:7680
    ds_read_b64_tr_b16 v[32:33], v16 offset:8192
    ds_read_b64_tr_b16 v[34:35], v16 offset:8704
    ds_read_b64_tr_b16 v[36:37], v16 offset:9216
    ds_read_b64_tr_b16 v[38:39], v16 offset:9728
    ds_read_b64_tr_b16 v[40:41], v16 offset:10240
    ds_read_b64_tr_b16 v[42:43], v16 offset:10752
    s_waitcnt lgkmcnt(6)
    v_mfma_f32_32x32x16_bf16 v[48:63], v[44:47], v[92:95], v[48:63]
    s_waitcnt lgkmcnt(4)
    v_mfma_f32_32x32x16_bf16 v[48:63], v[32:35], v[96:99], v[48:63]
    s_waitcnt lgkmcnt(2)
    v_mfma_f32_32x32x16_bf16 v[48:63], v[36:39], v[100:103], v[48:63]
    s_waitcnt lgkmcnt(0)
    v_mfma_f32_32x32x16_bf16 v[48:63], v[40:43], v[104:107], v[48:63]
    ds_read_b64_tr_b16 v[44:45], v16 offset:11264
    ds_read_b64_tr_b16 v[46:47], v16 offset:11776
    ds_read_b64_tr_b16 v[32:33], v16 offset:12288
    ds_read_b64_tr_b16 v[34:35], v16 offset:12800
    ds_read_b64_tr_b16 v[36:37], v16 offset:13312
    ds_read_b64_tr_b16 v[38:39], v16 offset:13824
    s_waitcnt lgkmcnt(4)
    v_mfma_f32_32x32x16_bf16 v[48:63], v[44:47], v[108:111], v[48:63]
    s_waitcnt lgkmcnt(2)
    v_mfma_f32_32x32x16_bf16 v[48:63], v[32:35], v[112:115], v[48:63]
    s_waitcnt lgkmcnt(0)
    v_mfma_f32_32x32x16_bf16 v[48:63], v[36:39], v[116:119], v[48:63]
    s_mov_b32 s61, 14336
    buffer_load_dwordx4 v[64:67], v20, s[40:43], s61 offen sc1
    s_mov_b32 s61, 15360
    buffer_load_dwordx4 v[68:71], v20, s[40:43], s61 offen sc1
    s_mov_b32 s61, 16384
    buffer_load_dwordx4 v[72:75], v20, s[40:43], s61 offen sc1
    s_mov_b32 s61, 17408
    buffer_load_dwordx4 v[76:79], v20, s[40:43], s61 offen sc1
    s_mov_b32 s61, 18432
    buffer_load_dwordx4 v[80:83], v20, s[40:43], s61 offen sc1
    s_mov_b32 s61, 19456
    buffer_load_dwordx4 v[84:87], v20, s[40:43], s61 offen sc1
    s_mov_b32 s61, 20480
    buffer_load_dwordx4 v[88:91], v20, s[40:43], s61 offen sc1
    s_waitcnt vmcnt(11)
    s_barrier
    s_add_u32 m0, s70, s75
    s_add_u32 s61, s63, 2097152
    buffer_load_dwordx4 v4, s[48:51], s63 offen sc1 lds
    buffer_load_dwordx4 v4, s[48:51], s63 offen offset:1024 sc1 lds
    s_add_u32 m0, m0, 2048
    s_add_u32 s63, s63, 2048
    buffer_load_dwordx4 v4, s[48:51], s61 offen sc1 lds
    buffer_load_dwordx4 v4, s[48:51], s61 offen offset:1024 sc1 lds
    s_add_u32 s70, s70, 16384
    s_and_b32 s70, s70, 0xffff
    s_mov_b32 s61, 21504
    buffer_load_dwordx4 v[92:95], v21, s[40:43], s61 offen sc1
    s_mov_b32 s61, 22528
    buffer_load_dwordx4 v[96:99], v21, s[40:43], s61 offen sc1
    s_mov_b32 s61, 23552
    buffer_load_dwordx4 v[100:103], v21, s[40:43], s61 offen sc1
    s_mov_b32 s61, 24576
    buffer_load_dwordx4 v[104:107], v21, s[40:43], s61 offen sc1
    s_mov_b32 s61, 25600
    buffer_load_dwordx4 v[108:111], v21, s[40:43], s61 offen sc1
    s_mov_b32 s61, 26624
    buffer_load_dwordx4 v[112:115], v21, s[40:43], s61 offen sc1
    s_mov_b32 s61, 27648
    buffer_load_dwordx4 v[116:119], v21, s[40:43], s61 offen sc1
    s_waitcnt vmcnt(18)
    s_barrier
    s_add_u32 m0, s70, s75
    s_add_u32 s61, s63, 2097152
    buffer_load_dwordx4 v4, s[48:51], s63 offen sc1 lds
    buffer_load_dwordx4 v4, s[48:51], s63 offen offset:1024 sc1 lds
    s_add_u32 m0, m0, 2048
    s_add_u32 s63, s63, 2048
    buffer_load_dwordx4 v4, s[48:51], s61 offen sc1 lds
    buffer_load_dwordx4 v4, s[48:51], s61 offen offset:1024 sc1 lds
    s_add_u32 s70, s70, 16384
    s_and_b32 s70, s70, 0xffff
    s_waitcnt vmcnt(11)
    s_barrier
    s_add_u32 m0, s70, s75
    s_add_u32 s61, s63, 2097152
    buffer_load_dwordx4 v4, s[48:51], s63 offen sc1 lds
    buffer_load_dwordx4 v4, s[48:51], s63 offen offset:1024 sc1 lds
    s_add_u32 m0, m0, 2048
    s_add_u32 s63, s63, 2048
    buffer_load_dwordx4 v4, s[48:51], s61 offen sc1 lds
    buffer_load_dwordx4 v4, s[48:51], s61 offen offset:1024 sc1 lds
    s_add_u32 s70, s70, 16384
    s_and_b32 s70, s70, 0xffff
    s_waitcnt vmcnt(4)
    s_barrier
    s_add_u32 m0, s70, s75
    s_add_u32 s61, s63, 2097152
    buffer_load_dwordx4 v4, s[48:51], s63 offen sc1 lds
    buffer_load_dwordx4 v4, s[48:51], s63 offen offset:1024 sc1 lds
    s_add_u32 m0, m0, 2048
    s_add_u32 s63, s63, 2048
    buffer_load_dwordx4 v4, s[48:51], s61 offen sc1 lds
    buffer_load_dwordx4 v4, s[48:51], s61 offen offset:1024 sc1 lds
    s_add_u32 s70, s70, 16384
    s_and_b32 s70, s70, 0xffff
    s_waitcnt vmcnt(12)
    ds_read_b64_tr_b16 v[40:41], v16 offset:14336
    ds_read_b64_tr_b16 v[42:43], v16 offset:14848
    ds_read_b64_tr_b16 v[44:45], v16 offset:15360
    ds_read_b64_tr_b16 v[46:47], v16 offset:15872
    ds_read_b64_tr_b16 v[32:33], v16 offset:16384
    ds_read_b64_tr_b16 v[34:35], v16 offset:16896
    ds_read_b64_tr_b16 v[36:37], v16 offset:17408
    ds_read_b64_tr_b16 v[38:39], v16 offset:17920
    s_waitcnt lgkmcnt(6)
    v_mfma_f32_32x32x16_bf16 v[48:63], v[40:43], v[64:67], v[48:63]
    s_waitcnt lgkmcnt(4)
    v_mfma_f32_32x32x16_bf16 v[48:63], v[44:47], v[68:71], v[48:63]
    s_waitcnt lgkmcnt(2)
    v_mfma_f32_32x32x16_bf16 v[48:63], v[32:35], v[72:75], v[48:63]
    s_waitcnt lgkmcnt(0)
    v_mfma_f32_32x32x16_bf16 v[48:63], v[36:39], v[76:79], v[48:63]
    ds_read_b64_tr_b16 v[40:41], v16 offset:18432
    ds_read_b64_tr_b16 v[42:43], v16 offset:18944
    ds_read_b64_tr_b16 v[44:45], v16 offset:19456
    ds_read_b64_tr_b16 v[46:47], v16 offset:19968
    ds_read_b64_tr_b16 v[32:33], v16 offset:20480
    ds_read_b64_tr_b16 v[34:35], v16 offset:20992
    s_waitcnt lgkmcnt(4)
    v_mfma_f32_32x32x16_bf16 v[48:63], v[40:43], v[80:83], v[48:63]
    s_waitcnt lgkmcnt(2)
    v_mfma_f32_32x32x16_bf16 v[48:63], v[44:47], v[84:87], v[48:63]
    s_waitcnt lgkmcnt(0)
    v_mfma_f32_32x32x16_bf16 v[48:63], v[32:35], v[88:91], v[48:63]
    s_waitcnt vmcnt(4)
    s_barrier
    s_add_u32 m0, s70, s75
    s_add_u32 s61, s63, 2097152
    buffer_load_dwordx4 v4, s[48:51], s63 offen sc1 lds
    buffer_load_dwordx4 v4, s[48:51], s63 offen offset:1024 sc1 lds
    s_add_u32 m0, m0, 2048
    s_add_u32 s63, s63, 2048
    buffer_load_dwordx4 v4, s[48:51], s61 offen sc1 lds
    buffer_load_dwordx4 v4, s[48:51], s61 offen offset:1024 sc1 lds
    s_add_u32 s70, s70, 16384
    s_and_b32 s70, s70, 0xffff
    ds_read_b64_tr_b16 v[36:37], v16 offset:21504
    ds_read_b64_tr_b16 v[38:39], v16 offset:22016
    ds_read_b64_tr_b16 v[40:41], v16 offset:22528
    ds_read_b64_tr_b16 v[42:43], v16 offset:23040
    ds_read_b64_tr_b16 v[44:45], v16 offset:23552
    ds_read_b64_tr_b16 v[46:47], v16 offset:24064
    ds_read_b64_tr_b16 v[32:33], v16 offset:24576
    ds_read_b64_tr_b16 v[34:35], v16 offset:25088
    s_waitcnt lgkmcnt(6)
    v_mfma_f32_32x32x16_bf16 v[48:63], v[36:39], v[92:95], v[48:63]
    s_waitcnt lgkmcnt(4)
    v_mfma_f32_32x32x16_bf16 v[48:63], v[40:43], v[96:99], v[48:63]
    s_waitcnt lgkmcnt(2)
    v_mfma_f32_32x32x16_bf16 v[48:63], v[44:47], v[100:103], v[48:63]
    s_waitcnt lgkmcnt(0)
    v_mfma_f32_32x32x16_bf16 v[48:63], v[32:35], v[104:107], v[48:63]
    ds_read_b64_tr_b16 v[36:37], v16 offset:25600
    ds_read_b64_tr_b16 v[38:39], v16 offset:26112
    ds_read_b64_tr_b16 v[40:41], v16 offset:26624
    ds_read_b64_tr_b16 v[42:43], v16 offset:27136
    ds_read_b64_tr_b16 v[44:45], v16 offset:27648
    ds_read_b64_tr_b16 v[46:47], v16 offset:28160
    s_waitcnt lgkmcnt(4)
    v_mfma_f32_32x32x16_bf16 v[48:63], v[36:39], v[108:111], v[48:63]
    s_waitcnt lgkmcnt(2)
    v_mfma_f32_32x32x16_bf16 v[48:63], v[40:43], v[112:115], v[48:63]
    s_waitcnt lgkmcnt(0)
    v_mfma_f32_32x32x16_bf16 v[48:63], v[44:47], v[116:119], v[48:63]
    s_waitcnt vmcnt(4)
    s_barrier
    s_add_u32 m0, s70, s75
    s_add_u32 s61, s63, 2097152
    buffer_load_dwordx4 v4, s[48:51], s63 offen sc1 lds
    buffer_load_dwordx4 v4, s[48:51], s63 offen offset:1024 sc1 lds
    s_add_u32 m0, m0, 2048
    s_add_u32 s63, s63, 2048
    buffer_load_dwordx4 v4, s[48:51], s61 offen sc1 lds
    buffer_load_dwordx4 v4, s[48:51], s61 offen offset:1024 sc1 lds
    s_add_u32 s70, s70, 16384
    s_and_b32 s70, s70, 0xffff
    s_nop 12
    s_cmp_eq_u32 s71, 1
    s_cbranch_scc1 K2_cs3
    v_mov_b32 v10, 0
    v_mov_b32 v11, 0
    v_lshlrev_b32 v8, 16, v22
    v_and_b32 v9, 0xffff0000, v22
    v_add_f32 v48, v48, v8
    v_add_f32 v49, v49, v9
    v_lshlrev_b32 v8, 16, v23
    v_and_b32 v9, 0xffff0000, v23
    v_add_f32 v50, v50, v8
    v_add_f32 v51, v51, v9
    v_lshlrev_b32 v8, 16, v24
    v_and_b32 v9, 0xffff0000, v24
    v_add_f32 v52, v52, v8
    v_add_f32 v53, v53, v9
    v_lshlrev_b32 v8, 16, v25
    v_and_b32 v9, 0xffff0000, v25
    v_add_f32 v54, v54, v8
    v_add_f32 v55, v55, v9
    v_lshlrev_b32 v8, 16, v26
    v_and_b32 v9, 0xffff0000, v26
    v_add_f32 v56, v56, v8
    v_add_f32 v57, v57, v9
    v_lshlrev_b32 v8, 16, v27
    v_and_b32 v9, 0xffff0000, v27
    v_add_f32 v58, v58, v8
    v_add_f32 v59, v59, v9
    v_lshlrev_b32 v8, 16, v28
    v_and_b32 v9, 0xffff0000, v28
    v_add_f32 v60, v60, v8
    v_add_f32 v61, v61, v9
    v_lshlrev_b32 v8, 16, v29
    v_and_b32 v9, 0xffff0000, v29
    v_add_f32 v62, v62, v8
    v_add_f32 v63, v63, v9
    v_add_f32 v10, v10, v48
    v_fmac_f32 v11, v48, v48
    v_add_f32 v10, v10, v49
    v_fmac_f32 v11, v49, v49
    v_add_f32 v10, v10, v50
    v_fmac_f32 v11, v50, v50
    v_add_f32 v10, v10, v51
    v_fmac_f32 v11, v51, v51
    v_add_f32 v10, v10, v52
    v_fmac_f32 v11, v52, v52
    v_add_f32 v10, v10, v53
    v_fmac_f32 v11, v53, v53
    v_add_f32 v10, v10, v54
    v_fmac_f32 v11, v54, v54
    v_add_f32 v10, v10, v55
    v_fmac_f32 v11, v55, v55
    v_add_f32 v10, v10, v56
    v_fmac_f32 v11, v56, v56
    v_add_f32 v10, v10, v57
    v_fmac_f32 v11, v57, v57
    v_add_f32 v10, v10, v58
    v_fmac_f32 v11, v58, v58
    v_add_f32 v10, v10, v59
    v_fmac_f32 v11, v59, v59
    v_add_f32 v10, v10, v60
    v_fmac_f32 v11, v60, v60
    v_add_f32 v10, v10, v61
    v_fmac_f32 v11, v61, v61
    v_add_f32 v10, v10, v62
    v_fmac_f32 v11, v62, v62
    v_add_f32 v10, v10, v63
    v_fmac_f32 v11, v63, v63
    v_cvt_pk_bf16_f32 v32, v48, v49
    v_cvt_pk_bf16_f32 v33, v50, v51
    v_cvt_pk_bf16_f32 v34, v52, v53
    v_cvt_pk_bf16_f32 v35, v54, v55
    v_cvt_pk_bf16_f32 v36, v56, v57
    v_cvt_pk_bf16_f32 v37, v58, v59
    v_cvt_pk_bf16_f32 v38, v60, v61
    v_cvt_pk_bf16_f32 v39, v62, v63
    s_lshr_b32 s62, s2, 5
    s_lshl_b32 s62, s62, 1
    s_add_u32 s62, s62, s73
    s_mul_i32 s61, s72, 28672
    s_lshl_b32 s74, s62, 11
    s_add_u32 s61, s61, s74
    s_add_u32 s61, s61, 11534336
    s_waitcnt vmcnt(4)
    s_barrier
    buffer_store_dwordx4 v[32:35], v4, s[48:51], s61 offen sc1
    buffer_store_dwordx4 v[36:39], v4, s[48:51], s61 offen offset:1024 sc1
    s_and_b32 s84, s2, 31
    s_mul_i32 s84, s84, 7
    s_lshr_b32 s74, s2, 5
    s_add_u32 s84, s84, s74
    s_lshl_b32 s84, s84, 2
    s_add_u32 s84, s84, s64
    s_lshl_b32 s84, s84, 2
    s_add_u32 s84, s84, 24190976
    v_mov_b32 v8, v10
    s_nop 1
    v_permlane32_swap_b32 v10, v8
    v_add_f32 v10, v10, v8
    v_mov_b32 v8, v11
    s_nop 1
    v_permlane32_swap_b32 v11, v8
    v_add_f32 v11, v11, v8
    s_lshl_b32 s61, s72, 5
    v_add_u32 v8, s61, v3
    v_mul_u32_u24 v8, 112, v8
    s_lshl_b32 s62, s62, 3
    s_add_u32 s62, s62, 22020096
    buffer_store_dwordx2 v[10:11], v8, s[48:51], s62 offen sc1
    s_waitcnt vmcnt(3)
    s_branch K2_ld_tail2
K2_cs3:
    s_sub_u32 s62, s2, 224
    s_lshl_b32 s62, s62, 1
    s_add_u32 s62, s62, s73
    s_lshl_b32 s62, s62, 7
    s_add_u32 s62, s62, 23068672
    v_lshlrev_b32 v8, 4, v2
    s_waitcnt vmcnt(4)
    s_barrier
    v_cmp_eq_u32 vcc, 0, v3
    s_and_saveexec_b64 s[58:59], vcc
    buffer_store_dwordx4 v[48:51], v8, s[48:51], s62 offen offset:0 sc1
    buffer_store_dwordx4 v[52:55], v8, s[48:51], s62 offen offset:32 sc1
    buffer_store_dwordx4 v[56:59], v8, s[48:51], s62 offen offset:64 sc1
    buffer_store_dwordx4 v[60:63], v8, s[48:51], s62 offen offset:96 sc1
    s_mov_b64 exec, s[58:59]
    s_sub_u32 s84, s2, 224
    s_lshl_b32 s84, s84, 2
    s_add_u32 s84, s84, s64
    s_lshl_b32 s84, s84, 2
    s_add_u32 s84, s84, 24195072
    s_waitcnt vmcnt(4)
    s_branch K2_ld_tail2
K2_comp:
    s_lshl_b32 s69, s69, 2
    s_and_b32 s61, s60, 1
    s_lshl_b32 s61, s61, 1
    s_add_u32 s69, s69, s61
    s_lshl_b32 s61, s68, 6
    s_add_u32 s61, s61, s69
    s_lshl_b32 s61, s61, 11
    buffer_load_dwordx4 v[20:23], v4, s[48:51], s61 offen offset:0 sc1
    buffer_load_dwordx4 v[24:27], v4, s[48:51], s61 offen offset:1024 sc1
    buffer_load_dwordx4 v[28:31], v4, s[48:51], s61 offen offset:2048 sc1
    buffer_load_dwordx4 v[32:35], v4, s[48:51], s61 offen offset:3072 sc1
    s_lshr_b32 s61, s60, 1
    s_lshl_b32 s61, s61, 12
    v_add_u32 v5, s61, v4
    v_mov_b32 v8, 122880
    v_mov_b32 v9, 0
    ds_write_b32 v8, v9
    s_mov_b32 s81, 0
K2_restart:
    v_mov_b32 v60, 0
    v_mov_b32 v61, 0
    v_mov_b32 v62, 0
    v_mov_b32 v63, 0
    v_mov_b32 v64, 0
    v_mov_b32 v65, 0
    v_mov_b32 v66, 0
    v_mov_b32 v67, 0
    v_mov_b32 v68, 0
    v_mov_b32 v69, 0
    v_mov_b32 v70, 0
    v_mov_b32 v71, 0
    v_mov_b32 v72, 0
    v_mov_b32 v73, 0
    v_mov_b32 v74, 0
    v_mov_b32 v75, 0
    v_mov_b32 v76, 0
    v_mov_b32 v77, 0
    v_mov_b32 v78, 0
    v_mov_b32 v79, 0
    v_mov_b32 v80, 0
    v_mov_b32 v81, 0
    v_mov_b32 v82, 0
    v_mov_b32 v83, 0
    v_mov_b32 v84, 0
    v_mov_b32 v85, 0
    v_mov_b32 v86, 0
    v_mov_b32 v87, 0
    v_mov_b32 v88, 0
    v_mov_b32 v89, 0
    v_mov_b32 v90, 0
    v_mov_b32 v91, 0
    v_mov_b32 v12, 0
    v_mov_b32 v13, 0
    v_mov_b32 v17, 0xff800000
    s_mov_b32 s67, 0xff800000
    s_mov_b32 s66, 0
    s_mov_b32 s65, 0
    v_cmp_lt_u32 vcc, 31, v1
    s_waitcnt vmcnt(0)
    v_cndmask_b32 v26, v26, 0, vcc
    v_cndmask_b32 v27, v27, 0, vcc
    v_cndmask_b32 v34, v34, 0, vcc
    v_cndmask_b32 v35, v35, 0, vcc
    s_mov_b32 s44, s30
    s_mov_b32 s45, s31
    s_mov_b32 s46, 1605632
    s_mov_b32 s47, 0x00020000
    s_mov_b32 s52, s20
    s_mov_b32 s53, s21
    s_mov_b32 s54, 401408
    s_mov_b32 s55, 0x00020000
    s_lshl_b32 s62, s2, 3
    s_add_u32 s62, s62, s60
    s_lshl_b32 s61, s62, 10
    buffer_load_dwordx4 v[156:159], v4, s[44:47], s61 offen
    s_lshl_b32 s61, s62, 10
    buffer_load_dwordx4 v[156:159], v4, s[52:55], s61 offen
    s_barrier
    ds_read_b128 v[44:47], v5
    ds_read_b128 v[48:51], v5 offset:1024
    s_waitcnt lgkmcnt(0)
    v_mfma_f32_32x32x16_bf16 v[92:107], v[44:47], v[20:23], 0
    v_mfma_f32_32x32x16_bf16 v[92:107], v[48:51], v[24:27], v[92:107]
    v_mfma_f32_32x32x16_bf16 v[108:123], v[44:47], v[28:31], 0
    v_mfma_f32_32x32x16_bf16 v[108:123], v[48:51], v[32:35], v[108:123]
    s_nop 7
    s_cmp_lg_u32 s81, 0
    s_cbranch_scc1 A_loop
    s_barrier
    v_add_u32 v6, s65, v5
    s_add_u32 s65, s65, 16384
    s_and_b32 s65, s65, 0xffff
    v_add_u32 v7, s65, v5
    ds_read_b128 v[44:47], v7
    ds_read_b128 v[48:51], v7 offset:1024
    ds_read_b128 v[52:55], v6 offset:2048
    ds_read_b128 v[56:59], v6 offset:3072
    v_max3_f32 v14, v92, v93, v94
    v_max3_f32 v8, v95, v96, v97
    v_max3_f32 v14, v14, v98, v99
    v_max3_f32 v8, v8, v100, v101
    v_max3_f32 v14, v14, v102, v103
    v_max3_f32 v8, v8, v104, v105
    v_max3_f32 v14, v14, v106, v107
    v_max3_f32 v15, v108, v109, v110
    v_max_f32 v14, v14, v8
    v_max3_f32 v8, v111, v112, v113
    v_max3_f32 v15, v15, v114, v115
    v_max3_f32 v8, v8, v116, v117
    v_max3_f32 v15, v15, v118, v119
    v_max3_f32 v8, v8, v120, v121
    v_max3_f32 v15, v15, v122, v123
    v_max_f32 v15, v15, v8
    v_max_f32 v8, v14, v15
    v_cmp_lt_f32 vcc, s67, v8
    s_cbranch_vccnz A_slow0f
A_ret0f:
    s_waitcnt lgkmcnt(2)
    v_mfma_f32_32x32x16_bf16 v[124:139], v[44:47], v[20:23], 0
    v_exp_f32 v92, v92
    v_exp_f32 v93, v93
    v_exp_f32 v94, v94
    v_exp_f32 v95, v95
    v_mfma_f32_32x32x16_bf16 v[140:155], v[44:47], v[28:31], 0
    v_exp_f32 v96, v96
    v_exp_f32 v97, v97
    v_exp_f32 v98, v98
    v_exp_f32 v99, v99
    v_exp_f32 v100, v100
    v_cvt_pk_bf16_f32 v36, v92, v93
    v_cvt_pk_bf16_f32 v37, v94, v95
    v_cvt_pk_bf16_f32 v38, v96, v97
    v_cvt_pk_bf16_f32 v39, v98, v99
    v_exp_f32 v101, v101
    s_waitcnt lgkmcnt(0)
    v_mfma_f32_32x32x16_bf16 v[60:75], v[52:55], v[36:39], v[60:75]
    v_exp_f32 v102, v102
    v_exp_f32 v103, v103
    v_exp_f32 v104, v104
    v_mfma_f32_32x32x16_bf16 v[124:139], v[48:51], v[24:27], v[124:139]
    v_exp_f32 v105, v105
    v_exp_f32 v106, v106
    v_exp_f32 v107, v107
    v_exp_f32 v108, v108
    v_cvt_pk_bf16_f32 v40, v100, v101
    v_cvt_pk_bf16_f32 v41, v102, v103
    v_cvt_pk_bf16_f32 v42, v104, v105
    v_cvt_pk_bf16_f32 v43, v106, v107
    v_exp_f32 v109, v109
    v_exp_f32 v110, v110
    v_mfma_f32_32x32x16_bf16 v[60:75], v[56:59], v[40:43], v[60:75]
    v_exp_f32 v111, v111
    v_exp_f32 v112, v112
    v_exp_f32 v113, v113
    v_mfma_f32_32x32x16_bf16 v[140:155], v[48:51], v[32:35], v[140:155]
    v_exp_f32 v114, v114
    v_exp_f32 v115, v115
    v_exp_f32 v116, v116
    v_cvt_pk_bf16_f32 v36, v108, v109
    v_cvt_pk_bf16_f32 v37, v110, v111
    v_cvt_pk_bf16_f32 v38, v112, v113
    v_cvt_pk_bf16_f32 v39, v114, v115
    v_exp_f32 v117, v117
    v_exp_f32 v118, v118
    v_mfma_f32_32x32x16_bf16 v[76:91], v[52:55], v[36:39], v[76:91]
    v_exp_f32 v119, v119
    v_exp_f32 v120, v120
    v_exp_f32 v121, v121
    v_exp_f32 v122, v122
    v_exp_f32 v123, v123
    s_add_u32 s66, s66, 1
    v_cvt_pk_bf16_f32 v40, v116, v117
    v_cvt_pk_bf16_f32 v41, v118, v119
    v_cvt_pk_bf16_f32 v42, v120, v121
    v_cvt_pk_bf16_f32 v43, v122, v123
    s_cmp_lt_u32 s66, 16
    s_nop 0
    v_mfma_f32_32x32x16_bf16 v[76:91], v[56:59], v[40:43], v[76:91]
.p2align 6
A_fast:
    s_barrier
    v_add_u32 v6, s65, v5
    s_add_u32 s65, s65, 16384
    s_and_b32 s65, s65, 0xffff
    v_add_u32 v7, s65, v5
    ds_read_b128 v[44:47], v7
    ds_read_b128 v[48:51], v7 offset:1024
    ds_read_b128 v[52:55], v6 offset:2048
    ds_read_b128 v[56:59], v6 offset:3072
    v_exp_f32 v124, v124
    v_exp_f32 v125, v125
    v_exp_f32 v126, v126
    v_exp_f32 v127, v127
    v_exp_f32 v128, v128
    v_exp_f32 v129, v129
    s_waitcnt lgkmcnt(2)
    v_mfma_f32_32x32x16_bf16 v[92:107], v[44:47], v[20:23], 0
    v_exp_f32 v130, v130
    v_exp_f32 v131, v131
    v_exp_f32 v132, v132
    v_mfma_f32_32x32x16_bf16 v[108:123], v[44:47], v[28:31], 0
    v_cvt_pk_bf16_f32 v36, v124, v125
    v_cvt_pk_bf16_f32 v37, v126, v127
    v_cvt_pk_bf16_f32 v38, v128, v129
    v_cvt_pk_bf16_f32 v39, v130, v131
    v_exp_f32 v133, v133
    s_waitcnt lgkmcnt(0)
    v_mfma_f32_32x32x16_bf16 v[60:75], v[52:55], v[36:39], v[60:75]
    v_exp_f32 v134, v134
    v_exp_f32 v135, v135
    v_exp_f32 v136, v136
    v_mfma_f32_32x32x16_bf16 v[92:107], v[48:51], v[24:27], v[92:107]
    v_exp_f32 v137, v137
    v_exp_f32 v138, v138
    v_exp_f32 v139, v139
    v_exp_f32 v140, v140
    v_cvt_pk_bf16_f32 v40, v132, v133
    v_cvt_pk_bf16_f32 v41, v134, v135
    v_cvt_pk_bf16_f32 v42, v136, v137
    v_cvt_pk_bf16_f32 v43, v138, v139
    v_exp_f32 v141, v141
    v_exp_f32 v142, v142
    v_mfma_f32_32x32x16_bf16 v[60:75], v[56:59], v[40:43], v[60:75]
    v_exp_f32 v143, v143
    v_exp_f32 v144, v144
    v_exp_f32 v145, v145
    v_mfma_f32_32x32x16_bf16 v[108:123], v[48:51], v[32:35], v[108:123]
    v_exp_f32 v146, v146
    v_exp_f32 v147, v147
    v_exp_f32 v148, v148
    v_cvt_pk_bf16_f32 v36, v140, v141
    v_cvt_pk_bf16_f32 v37, v142, v143
    v_cvt_pk_bf16_f32 v38, v144, v145
    v_cvt_pk_bf16_f32 v39, v146, v147
    v_exp_f32 v149, v149
    v_exp_f32 v150, v150
    v_mfma_f32_32x32x16_bf16 v[76:91], v[52:55], v[36:39], v[76:91]
    v_exp_f32 v151, v151
    v_exp_f32 v152, v152
    v_exp_f32 v153, v153
    v_exp_f32 v154, v154
    v_exp_f32 v155, v155
    s_add_u32 s66, s66, 1
    v_cvt_pk_bf16_f32 v40, v148, v149
    v_cvt_pk_bf16_f32 v41, v150, v151
    v_cvt_pk_bf16_f32 v42, v152, v153
    v_cvt_pk_bf16_f32 v43, v154, v155
    s_cmp_lt_u32 s66, 16
    s_nop 0
    v_mfma_f32_32x32x16_bf16 v[76:91], v[56:59], v[40:43], v[76:91]
    s_cmp_lt_u32 s66, 16
    s_cbranch_scc0 A_check
    s_barrier
    v_add_u32 v6, s65, v5
    s_add_u32 s65, s65, 16384
    s_and_b32 s65, s65, 0xffff
    v_add_u32 v7, s65, v5
    ds_read_b128 v[44:47], v7
    ds_read_b128 v[48:51], v7 offset:1024
    ds_read_b128 v[52:55], v6 offset:2048
    ds_read_b128 v[56:59], v6 offset:3072
    v_exp_f32 v92, v92
    v_exp_f32 v93, v93
    v_exp_f32 v94, v94
    v_exp_f32 v95, v95
    v_exp_f32 v96, v96
    v_exp_f32 v97, v97
    s_waitcnt lgkmcnt(2)
    v_mfma_f32_32x32x16_bf16 v[124:139], v[44:47], v[20:23], 0
    v_exp_f32 v98, v98
    v_exp_f32 v99, v99
    v_exp_f32 v100, v100
    v_mfma_f32_32x32x16_bf16 v[140:155], v[44:47], v[28:31], 0
    v_cvt_pk_bf16_f32 v36, v92, v93
    v_cvt_pk_bf16_f32 v37, v94, v95
    v_cvt_pk_bf16_f32 v38, v96, v97
    v_cvt_pk_bf16_f32 v39, v98, v99
    v_exp_f32 v101, v101
    s_waitcnt lgkmcnt(0)
    v_mfma_f32_32x32x16_bf16 v[60:75], v[52:55], v[36:39], v[60:75]
    v_exp_f32 v102, v102
    v_exp_f32 v103, v103
    v_exp_f32 v104, v104
    v_mfma_f32_32x32x16_bf16 v[124:139], v[48:51], v[24:27], v[124:139]
    v_exp_f32 v105, v105
    v_exp_f32 v106, v106
    v_exp_f32 v107, v107
    v_exp_f32 v108, v108
    v_cvt_pk_bf16_f32 v40, v100, v101
    v_cvt_pk_bf16_f32 v41, v102, v103
    v_cvt_pk_bf16_f32 v42, v104, v105
    v_cvt_pk_bf16_f32 v43, v106, v107
    v_exp_f32 v109, v109
    v_exp_f32 v110, v110
    v_mfma_f32_32x32x16_bf16 v[60:75], v[56:59], v[40:43], v[60:75]
    v_exp_f32 v111, v111
    v_exp_f32 v112, v112
    v_exp_f32 v113, v113
    v_mfma_f32_32x32x16_bf16 v[140:155], v[48:51], v[32:35], v[140:155]
    v_exp_f32 v114, v114
    v_exp_f32 v115, v115
    v_exp_f32 v116, v116
    v_cvt_pk_bf16_f32 v36, v108, v109
    v_cvt_pk_bf16_f32 v37, v110, v111
    v_cvt_pk_bf16_f32 v38, v112, v113
    v_cvt_pk_bf16_f32 v39, v114, v115
    v_exp_f32 v117, v117
    v_exp_f32 v118, v118
    v_mfma_f32_32x32x16_bf16 v[76:91], v[52:55], v[36:39], v[76:91]
    v_exp_f32 v119, v119
    v_exp_f32 v120, v120
    v_exp_f32 v121, v121
    v_exp_f32 v122, v122
    v_exp_f32 v123, v123
    s_add_u32 s66, s66, 1
    v_cvt_pk_bf16_f32 v40, v116, v117
    v_cvt_pk_bf16_f32 v41, v118, v119
    v_cvt_pk_bf16_f32 v42, v120, v121
    v_cvt_pk_bf16_f32 v43, v122, v123
    s_cmp_lt_u32 s66, 16
    s_nop 0
    v_mfma_f32_32x32x16_bf16 v[76:91], v[56:59], v[40:43], v[76:91]
    s_branch A_fast
A_check:
    v_mov_b32 v8, 0
    s_nop 10
    v_fmac_f32 v8, 0, v60
    v_fmac_f32 v8, 0, v61
    v_fmac_f32 v8, 0, v62
    v_fmac_f32 v8, 0, v63
    v_fmac_f32 v8, 0, v64
    v_fmac_f32 v8, 0, v65
    v_fmac_f32 v8, 0, v66
    v_fmac_f32 v8, 0, v67
    v_fmac_f32 v8, 0, v68
    v_fmac_f32 v8, 0, v69
    v_fmac_f32 v8, 0, v70
    v_fmac_f32 v8, 0, v71
    v_fmac_f32 v8, 0, v72
    v_fmac_f32 v8, 0, v73
    v_fmac_f32 v8, 0, v74
    v_fmac_f32 v8, 0, v75
    v_fmac_f32 v8, 0, v76
    v_fmac_f32 v8, 0, v77
    v_fmac_f32 v8, 0, v78
    v_fmac_f32 v8, 0, v79
    v_fmac_f32 v8, 0, v80
    v_fmac_f32 v8, 0, v81
    v_fmac_f32 v8, 0, v82
    v_fmac_f32 v8, 0, v83
    v_fmac_f32 v8, 0, v84
    v_fmac_f32 v8, 0, v85
    v_fmac_f32 v8, 0, v86
    v_fmac_f32 v8, 0, v87
    v_fmac_f32 v8, 0, v88
    v_fmac_f32 v8, 0, v89
    v_fmac_f32 v8, 0, v90
    v_fmac_f32 v8, 0, v91
    v_cmp_u_f32 vcc, v8, v8
    s_cbranch_vccz A_end
    v_mov_b32 v8, 122880
    v_mov_b32 v9, 1
    ds_write_b32 v8, v9
    s_waitcnt lgkmcnt(0)
    s_branch A_end
.p2align 6
A_loop:
    s_barrier
    v_add_u32 v6, s65, v5
    s_add_u32 s65, s65, 16384
    s_and_b32 s65, s65, 0xffff
    v_add_u32 v7, s65, v5
    ds_read_b128 v[44:47], v7
    ds_read_b128 v[48:51], v7 offset:1024
    ds_read_b128 v[52:55], v6 offset:2048
    ds_read_b128 v[56:59], v6 offset:3072
    v_max3_f32 v14, v92, v93, v94
    v_max3_f32 v8, v95, v96, v97
    v_max3_f32 v14, v14, v98, v99
    v_max3_f32 v8, v8, v100, v101
    v_max3_f32 v14, v14, v102, v103
    v_max3_f32 v8, v8, v104, v105
    v_max3_f32 v14, v14, v106, v107
    v_max3_f32 v15, v108, v109, v110
    v_max_f32 v14, v14, v8
    v_max3_f32 v8, v111, v112, v113
    v_max3_f32 v15, v15, v114, v115
    v_max3_f32 v8, v8, v116, v117
    v_max3_f32 v15, v15, v118, v119
    v_max3_f32 v8, v8, v120, v121
    v_max3_f32 v15, v15, v122, v123
    v_max_f32 v15, v15, v8
    v_max_f32 v8, v14, v15
    v_cmp_lt_f32 vcc, s67, v8
    s_cbranch_vccnz A_slow0
A_ret0:
    s_waitcnt lgkmcnt(2)
    v_mfma_f32_32x32x16_bf16 v[124:139], v[44:47], v[20:23], 0
    v_exp_f32 v92, v92
    v_exp_f32 v93, v93
    v_exp_f32 v94, v94
    v_exp_f32 v95, v95
    v_mfma_f32_32x32x16_bf16 v[140:155], v[44:47], v[28:31], 0
    v_exp_f32 v96, v96
    v_exp_f32 v97, v97
    v_exp_f32 v98, v98
    v_exp_f32 v99, v99
    v_exp_f32 v100, v100
    v_cvt_pk_bf16_f32 v36, v92, v93
    v_cvt_pk_bf16_f32 v37, v94, v95
    v_cvt_pk_bf16_f32 v38, v96, v97
    v_cvt_pk_bf16_f32 v39, v98, v99
    v_exp_f32 v101, v101
    s_waitcnt lgkmcnt(0)
    v_mfma_f32_32x32x16_bf16 v[60:75], v[52:55], v[36:39], v[60:75]
    v_exp_f32 v102, v102
    v_exp_f32 v103, v103
    v_exp_f32 v104, v104
    v_mfma_f32_32x32x16_bf16 v[124:139], v[48:51], v[24:27], v[124:139]
    v_exp_f32 v105, v105
    v_exp_f32 v106, v106
    v_exp_f32 v107, v107
    v_exp_f32 v108, v108
    v_cvt_pk_bf16_f32 v40, v100, v101
    v_cvt_pk_bf16_f32 v41, v102, v103
    v_cvt_pk_bf16_f32 v42, v104, v105
    v_cvt_pk_bf16_f32 v43, v106, v107
    v_exp_f32 v109, v109
    v_exp_f32 v110, v110
    v_mfma_f32_32x32x16_bf16 v[60:75], v[56:59], v[40:43], v[60:75]
    v_exp_f32 v111, v111
    v_exp_f32 v112, v112
    v_exp_f32 v113, v113
    v_mfma_f32_32x32x16_bf16 v[140:155], v[48:51], v[32:35], v[140:155]
    v_exp_f32 v114, v114
    v_exp_f32 v115, v115
    v_exp_f32 v116, v116
    v_cvt_pk_bf16_f32 v36, v108, v109
    v_cvt_pk_bf16_f32 v37, v110, v111
    v_cvt_pk_bf16_f32 v38, v112, v113
    v_cvt_pk_bf16_f32 v39, v114, v115
    v_exp_f32 v117, v117
    v_exp_f32 v118, v118
    v_mfma_f32_32x32x16_bf16 v[76:91], v[52:55], v[36:39], v[76:91]
    v_exp_f32 v119, v119
    v_exp_f32 v120, v120
    v_exp_f32 v121, v121
    v_exp_f32 v122, v122
    v_exp_f32 v123, v123
    s_add_u32 s66, s66, 1
    v_cvt_pk_bf16_f32 v40, v116, v117
    v_cvt_pk_bf16_f32 v41, v118, v119
    v_cvt_pk_bf16_f32 v42, v120, v121
    v_cvt_pk_bf16_f32 v43, v122, v123
    s_cmp_lt_u32 s66, 16
    s_nop 0
    v_mfma_f32_32x32x16_bf16 v[76:91], v[56:59], v[40:43], v[76:91]
    s_barrier
    v_add_u32 v6, s65, v5
    s_add_u32 s65, s65, 16384
    s_and_b32 s65, s65, 0xffff
    v_add_u32 v7, s65, v5
    ds_read_b128 v[44:47], v7
    ds_read_b128 v[48:51], v7 offset:1024
    ds_read_b128 v[52:55], v6 offset:2048
    ds_read_b128 v[56:59], v6 offset:3072
    v_max3_f32 v14, v124, v125, v126
    v_max3_f32 v8, v127, v128, v129
    v_max3_f32 v14, v14, v130, v131
    v_max3_f32 v8, v8, v132, v133
    v_max3_f32 v14, v14, v134, v135
    v_max3_f32 v8, v8, v136, v137
    v_max3_f32 v14, v14, v138, v139
    v_max3_f32 v15, v140, v141, v142
    v_max_f32 v14, v14, v8
    v_max3_f32 v8, v143, v144, v145
    v_max3_f32 v15, v15, v146, v147
    v_max3_f32 v8, v8, v148, v149
    v_max3_f32 v15, v15, v150, v151
    v_max3_f32 v8, v8, v152, v153
    v_max3_f32 v15, v15, v154, v155
    v_max_f32 v15, v15, v8
    v_max_f32 v8, v14, v15
    v_cmp_lt_f32 vcc, s67, v8
    s_cbranch_vccnz A_slow1
A_ret1:
    s_waitcnt lgkmcnt(2)
    v_mfma_f32_32x32x16_bf16 v[92:107], v[44:47], v[20:23], 0
    v_exp_f32 v124, v124
    v_exp_f32 v125, v125
    v_exp_f32 v126, v126
    v_exp_f32 v127, v127
    v_mfma_f32_32x32x16_bf16 v[108:123], v[44:47], v[28:31], 0
    v_exp_f32 v128, v128
    v_exp_f32 v129, v129
    v_exp_f32 v130, v130
    v_exp_f32 v131, v131
    v_exp_f32 v132, v132
    v_cvt_pk_bf16_f32 v36, v124, v125
    v_cvt_pk_bf16_f32 v37, v126, v127
    v_cvt_pk_bf16_f32 v38, v128, v129
    v_cvt_pk_bf16_f32 v39, v130, v131
    v_exp_f32 v133, v133
    s_waitcnt lgkmcnt(0)
    v_mfma_f32_32x32x16_bf16 v[60:75], v[52:55], v[36:39], v[60:75]
    v_exp_f32 v134, v134
    v_exp_f32 v135, v135
    v_exp_f32 v136, v136
    v_mfma_f32_32x32x16_bf16 v[92:107], v[48:51], v[24:27], v[92:107]
    v_exp_f32 v137, v137
    v_exp_f32 v138, v138
    v_exp_f32 v139, v139
    v_exp_f32 v140, v140
    v_cvt_pk_bf16_f32 v40, v132, v133
    v_cvt_pk_bf16_f32 v41, v134, v135
    v_cvt_pk_bf16_f32 v42, v136, v137
    v_cvt_pk_bf16_f32 v43, v138, v139
    v_exp_f32 v141, v141
    v_exp_f32 v142, v142
    v_mfma_f32_32x32x16_bf16 v[60:75], v[56:59], v[40:43], v[60:75]
    v_exp_f32 v143, v143
    v_exp_f32 v144, v144
    v_exp_f32 v145, v145
    v_mfma_f32_32x32x16_bf16 v[108:123], v[48:51], v[32:35], v[108:123]
    v_exp_f32 v146, v146
    v_exp_f32 v147, v147
    v_exp_f32 v148, v148
    v_cvt_pk_bf16_f32 v36, v140, v141
    v_cvt_pk_bf16_f32 v37, v142, v143
    v_cvt_pk_bf16_f32 v38, v144, v145
    v_cvt_pk_bf16_f32 v39, v146, v147
    v_exp_f32 v149, v149
    v_exp_f32 v150, v150
    v_mfma_f32_32x32x16_bf16 v[76:91], v[52:55], v[36:39], v[76:91]
    v_exp_f32 v151, v151
    v_exp_f32 v152, v152
    v_exp_f32 v153, v153
    v_exp_f32 v154, v154
    v_exp_f32 v155, v155
    s_add_u32 s66, s66, 1
    v_cvt_pk_bf16_f32 v40, v148, v149
    v_cvt_pk_bf16_f32 v41, v150, v151
    v_cvt_pk_bf16_f32 v42, v152, v153
    v_cvt_pk_bf16_f32 v43, v154, v155
    s_cmp_lt_u32 s66, 16
    s_nop 0
    v_mfma_f32_32x32x16_bf16 v[76:91], v[56:59], v[40:43], v[76:91]
    s_cbranch_scc1 A_loop
A_end:
    s_barrier
    v_mov_b32 v8, 122880
    ds_read_b32 v9, v8
    s_waitcnt lgkmcnt(0)
    v_readfirstlane_b32 s61, v9
    s_cmp_lg_u32 s81, 0
    s_cbranch_scc1 A_fin
    s_cmp_eq_u32 s61, 0
    s_cbranch_scc1 A_fin
    s_mov_b32 s81, 1
    s_branch K2_restart
A_fin:
    s_mul_i32 s61, s60, 9216
    v_add_u32 v8, s61, v4
    v_lshlrev_b32 v9, 2, v1
    v_add_u32 v9, s61, v9
    s_nop 8
    ds_write_b128 v8, v[60:63] offset:0
    ds_write_b128 v8, v[64:67] offset:1024
    ds_write_b128 v8, v[68:71] offset:2048
    ds_write_b128 v8, v[72:75] offset:3072
    ds_write_b128 v8, v[76:79] offset:4608
    ds_write_b128 v8, v[80:83] offset:5632
    ds_write_b128 v8, v[84:87] offset:6656
    ds_write_b128 v8, v[88:91] offset:7680
    ds_write_b32 v9, v12 offset:4096
    ds_write_b32 v9, v13 offset:8704
    s_waitcnt lgkmcnt(0)
    s_barrier
    s_cmp_lt_u32 s60, 4
    s_cbranch_scc1 K2_owner
    s_barrier
    s_branch K23_mid
K2_owner:
    s_and_b32 s61, s60, 1
    s_mul_i32 s61, s61, 9216
    s_lshr_b32 s62, s60, 1
    s_mul_i32 s74, s62, 4608
    s_add_u32 s61, s61, s74
    v_add_u32 v8, s61, v4
    v_lshlrev_b32 v9, 2, v1
    v_add_u32 v9, s61, v9
    ds_read_b32 v20, v9 offset:4096
    ds_read_b32 v21, v9 offset:22528
    ds_read_b32 v22, v9 offset:40960
    ds_read_b32 v23, v9 offset:59392
    ds_read_b128 v[92:95], v8 offset:0
    ds_read_b128 v[96:99], v8 offset:1024
    ds_read_b128 v[100:103], v8 offset:2048
    ds_read_b128 v[104:107], v8 offset:3072
    ds_read_b128 v[108:111], v8 offset:18432
    ds_read_b128 v[112:115], v8 offset:19456
    ds_read_b128 v[116:119], v8 offset:20480
    ds_read_b128 v[120:123], v8 offset:21504
    ds_read_b128 v[124:127], v8 offset:36864
    ds_read_b128 v[128:131], v8 offset:37888
    ds_read_b128 v[132:135], v8 offset:38912
    ds_read_b128 v[136:139], v8 offset:39936
    ds_read_b128 v[140:143], v8 offset:55296
    ds_read_b128 v[144:147], v8 offset:56320
    ds_read_b128 v[148:151], v8 offset:57344
    ds_read_b128 v[152:155], v8 offset:58368
    s_waitcnt lgkmcnt(0)
    s_barrier
    v_max3_f32 v10, v20, v21, v22
    v_max_f32 v10, v10, v23
    v_sub_f32 v20, v20, v10
    v_sub_f32 v21, v21, v10
    v_sub_f32 v22, v22, v10
    v_sub_f32 v23, v23, v10
    v_exp_f32 v20, v20
    v_exp_f32 v21, v21
    v_exp_f32 v22, v22
    v_exp_f32 v23, v23
    s_nop 0
    v_mul_f32 v92, v92, v20
    v_mul_f32 v93, v93, v20
    v_mul_f32 v94, v94, v20
    v_mul_f32 v95, v95, v20
    v_mul_f32 v96, v96, v20
    v_mul_f32 v97, v97, v20
    v_mul_f32 v98, v98, v20
    v_mul_f32 v99, v99, v20
    v_mul_f32 v100, v100, v20
    v_mul_f32 v101, v101, v20
    v_mul_f32 v102, v102, v20
    v_mul_f32 v103, v103, v20
    v_mul_f32 v104, v104, v20
    v_mul_f32 v105, v105, v20
    v_mul_f32 v106, v106, v20
    v_mul_f32 v107, v107, v20
    v_fmac_f32 v92, v108, v21
    v_fmac_f32 v93, v109, v21
    v_fmac_f32 v94, v110, v21
    v_fmac_f32 v95, v111, v21
    v_fmac_f32 v96, v112, v21
    v_fmac_f32 v97, v113, v21
    v_fmac_f32 v98, v114, v21
    v_fmac_f32 v99, v115, v21
    v_fmac_f32 v100, v116, v21
    v_fmac_f32 v101, v117, v21
    v_fmac_f32 v102, v118, v21
    v_fmac_f32 v103, v119, v21
    v_fmac_f32 v104, v120, v21
    v_fmac_f32 v105, v121, v21
    v_fmac_f32 v106, v122, v21
    v_fmac_f32 v107, v123, v21
    v_fmac_f32 v92, v124, v22
    v_fmac_f32 v93, v125, v22
    v_fmac_f32 v94, v126, v22
    v_fmac_f32 v95, v127, v22
    v_fmac_f32 v96, v128, v22
    v_fmac_f32 v97, v129, v22
    v_fmac_f32 v98, v130, v22
    v_fmac_f32 v99, v131, v22
    v_fmac_f32 v100, v132, v22
    v_fmac_f32 v101, v133, v22
    v_fmac_f32 v102, v134, v22
    v_fmac_f32 v103, v135, v22
    v_fmac_f32 v104, v136, v22
    v_fmac_f32 v105, v137, v22
    v_fmac_f32 v106, v138, v22
    v_fmac_f32 v107, v139, v22
    v_fmac_f32 v92, v140, v23
    v_fmac_f32 v93, v141, v23
    v_fmac_f32 v94, v142, v23
    v_fmac_f32 v95, v143, v23
    v_fmac_f32 v96, v144, v23
    v_fmac_f32 v97, v145, v23
    v_fmac_f32 v98, v146, v23
    v_fmac_f32 v99, v147, v23
    v_fmac_f32 v100, v148, v23
    v_fmac_f32 v101, v149, v23
    v_fmac_f32 v102, v150, v23
    v_fmac_f32 v103, v151, v23
    v_fmac_f32 v104, v152, v23
    v_fmac_f32 v105, v153, v23
    v_fmac_f32 v106, v154, v23
    v_fmac_f32 v107, v155, v23
    v_mov_b32 v9, v104
    v_mov_b32 v10, v104
    s_nop 1
    v_permlane32_swap_b32 v9, v10
    v_rcp_f32 v10, v10
    v_cmp_lt_u32 vcc, 31, v1
    v_mul_f32 v92, v92, v10
    v_mul_f32 v93, v93, v10
    v_mul_f32 v94, v94, v10
    v_mul_f32 v95, v95, v10
    v_mul_f32 v96, v96, v10
    v_mul_f32 v97, v97, v10
    v_mul_f32 v98, v98, v10
    v_mul_f32 v99, v99, v10
    v_mul_f32 v100, v100, v10
    v_mul_f32 v101, v101, v10
    v_mul_f32 v102, v102, v10
    v_mul_f32 v103, v103, v10
    v_mul_f32 v104, v104, v10
    v_mul_f32 v105, v105, v10
    v_mul_f32 v106, v106, v10
    v_mul_f32 v107, v107, v10
    v_cvt_pk_bf16_f32 v24, v92, v93
    v_cvt_pk_bf16_f32 v25, v94, v95
    v_cvt_pk_bf16_f32 v26, v96, v97
    v_cvt_pk_bf16_f32 v27, v98, v99
    v_cvt_pk_bf16_f32 v28, v100, v101
    v_cvt_pk_bf16_f32 v29, v102, v103
    v_cvt_pk_bf16_f32 v30, v104, v105
    v_cvt_pk_bf16_f32 v31, v106, v107
    v_cndmask_b32 v30, v30, 0, vcc
    v_cndmask_b32 v31, v31, 0, vcc
    s_add_u32 s61, s69, s62
    s_lshl_b32 s61, s61, 4
    s_add_u32 s61, s61, s68
    s_lshl_b32 s61, s61, 11
    s_add_u32 s61, s61, 9437184
    buffer_store_dwordx4 v[24:27], v4, s[48:51], s61 offen sc1
    buffer_store_dwordx4 v[28:31], v4, s[48:51], s61 offen offset:1024 sc1
    s_lshr_b32 s61, s2, 4
    s_lshl_b32 s61, s61, 4
    s_add_u32 s61, s61, s68
    s_lshl_b32 s61, s61, 2
    s_add_u32 s61, s61, s60
    s_lshl_b32 s61, s61, 2
    s_add_u32 s61, s61, 24199168
    s_waitcnt vmcnt(0)
    v_mov_b32 v8, 0
    v_mov_b32 v9, s95
    v_cmp_eq_u32 vcc, 0, v1
    s_and_saveexec_b64 s[86:87], vcc
    buffer_store_dword v9, v8, s[48:51], s61 offen sc1
    s_mov_b64 exec, s[86:87]
    s_branch K23_mid
A_slow0:
    v_cmp_lt_u32 vcc, 31, v1
    v_mov_b32 v8, v14
    s_nop 1
    v_permlane32_swap_b32 v14, v8
    s_nop 1
    v_max3_f32 v14, v14, v8, v17
    v_add_f32 v12, v12, v14
    v_max_f32 v8, 0, v14
    v_exp_f32 v8, -v8
    v_sub_f32 v92, v92, v14
    v_sub_f32 v93, v93, v14
    v_sub_f32 v94, v94, v14
    v_sub_f32 v95, v95, v14
    v_sub_f32 v96, v96, v14
    v_sub_f32 v97, v97, v14
    v_sub_f32 v98, v98, v14
    v_sub_f32 v99, v99, v14
    v_sub_f32 v100, v100, v14
    v_sub_f32 v101, v101, v14
    v_sub_f32 v102, v102, v14
    v_sub_f32 v103, v103, v14
    v_sub_f32 v104, v104, v14
    v_sub_f32 v105, v105, v14
    v_sub_f32 v106, v106, v14
    v_sub_f32 v107, v107, v14
    v_mul_f32 v60, v60, v8
    v_mul_f32 v61, v61, v8
    v_mul_f32 v62, v62, v8
    v_mul_f32 v63, v63, v8
    v_mul_f32 v64, v64, v8
    v_mul_f32 v65, v65, v8
    v_mul_f32 v66, v66, v8
    v_mul_f32 v67, v67, v8
    v_mul_f32 v68, v68, v8
    v_mul_f32 v69, v69, v8
    v_mul_f32 v70, v70, v8
    v_mul_f32 v71, v71, v8
    v_mul_f32 v72, v72, v8
    v_mul_f32 v73, v73, v8
    v_mul_f32 v74, v74, v8
    v_mul_f32 v75, v75, v8
    v_sub_f32 v8, 0, v12
    v_cvt_pk_bf16_f32 v9, v8, v8
    v_and_b32 v9, 0xffff0000, v9
    v_sub_f32 v8, v8, v9
    v_cvt_pk_bf16_f32 v10, v8, v8
    v_and_b32 v10, 0xffff0000, v10
    v_sub_f32 v8, v8, v10
    v_cvt_pk_bf16_f32 v9, v9, v10
    v_cvt_pk_bf16_f32 v10, v8, 0
    v_cndmask_b32 v26, v26, v9, vcc
    v_cndmask_b32 v27, v27, v10, vcc
    v_mov_b32 v8, v15
    s_nop 1
    v_permlane32_swap_b32 v15, v8
    s_nop 1
    v_max3_f32 v15, v15, v8, v17
    v_add_f32 v13, v13, v15
    v_max_f32 v8, 0, v15
    v_exp_f32 v8, -v8
    v_sub_f32 v108, v108, v15
    v_sub_f32 v109, v109, v15
    v_sub_f32 v110, v110, v15
    v_sub_f32 v111, v111, v15
    v_sub_f32 v112, v112, v15
    v_sub_f32 v113, v113, v15
    v_sub_f32 v114, v114, v15
    v_sub_f32 v115, v115, v15
    v_sub_f32 v116, v116, v15
    v_sub_f32 v117, v117, v15
    v_sub_f32 v118, v118, v15
    v_sub_f32 v119, v119, v15
    v_sub_f32 v120, v120, v15
    v_sub_f32 v121, v121, v15
    v_sub_f32 v122, v122, v15
    v_sub_f32 v123, v123, v15
    v_mul_f32 v76, v76, v8
    v_mul_f32 v77, v77, v8
    v_mul_f32 v78, v78, v8
    v_mul_f32 v79, v79, v8
    v_mul_f32 v80, v80, v8
    v_mul_f32 v81, v81, v8
    v_mul_f32 v82, v82, v8
    v_mul_f32 v83, v83, v8
    v_mul_f32 v84, v84, v8
    v_mul_f32 v85, v85, v8
    v_mul_f32 v86, v86, v8
    v_mul_f32 v87, v87, v8
    v_mul_f32 v88, v88, v8
    v_mul_f32 v89, v89, v8
    v_mul_f32 v90, v90, v8
    v_mul_f32 v91, v91, v8
    v_sub_f32 v8, 0, v13
    v_cvt_pk_bf16_f32 v9, v8, v8
    v_and_b32 v9, 0xffff0000, v9
    v_sub_f32 v8, v8, v9
    v_cvt_pk_bf16_f32 v10, v8, v8
    v_and_b32 v10, 0xffff0000, v10
    v_sub_f32 v8, v8, v10
    v_cvt_pk_bf16_f32 v9, v9, v10
    v_cvt_pk_bf16_f32 v10, v8, 0
    v_cndmask_b32 v34, v34, v9, vcc
    v_cndmask_b32 v35, v35, v10, vcc
    v_mov_b32 v17, 0
    s_mov_b32 s67, 0x42000000
    s_branch A_ret0
A_slow1:
    v_cmp_lt_u32 vcc, 31, v1
    v_mov_b32 v8, v14
    s_nop 1
    v_permlane32_swap_b32 v14, v8
    s_nop 1
    v_max3_f32 v14, v14, v8, v17
    v_add_f32 v12, v12, v14
    v_max_f32 v8, 0, v14
    v_exp_f32 v8, -v8
    v_sub_f32 v124, v124, v14
    v_sub_f32 v125, v125, v14
    v_sub_f32 v126, v126, v14
    v_sub_f32 v127, v127, v14
    v_sub_f32 v128, v128, v14
    v_sub_f32 v129, v129, v14
    v_sub_f32 v130, v130, v14
    v_sub_f32 v131, v131, v14
    v_sub_f32 v132, v132, v14
    v_sub_f32 v133, v133, v14
    v_sub_f32 v134, v134, v14
    v_sub_f32 v135, v135, v14
    v_sub_f32 v136, v136, v14
    v_sub_f32 v137, v137, v14
    v_sub_f32 v138, v138, v14
    v_sub_f32 v139, v139, v14
    v_mul_f32 v60, v60, v8
    v_mul_f32 v61, v61, v8
    v_mul_f32 v62, v62, v8
    v_mul_f32 v63, v63, v8
    v_mul_f32 v64, v64, v8
    v_mul_f32 v65, v65, v8
    v_mul_f32 v66, v66, v8
    v_mul_f32 v67, v67, v8
    v_mul_f32 v68, v68, v8
    v_mul_f32 v69, v69, v8
    v_mul_f32 v70, v70, v8
    v_mul_f32 v71, v71, v8
    v_mul_f32 v72, v72, v8
    v_mul_f32 v73, v73, v8
    v_mul_f32 v74, v74, v8
    v_mul_f32 v75, v75, v8
    v_sub_f32 v8, 0, v12
    v_cvt_pk_bf16_f32 v9, v8, v8
    v_and_b32 v9, 0xffff0000, v9
    v_sub_f32 v8, v8, v9
    v_cvt_pk_bf16_f32 v10, v8, v8
    v_and_b32 v10, 0xffff0000, v10
    v_sub_f32 v8, v8, v10
    v_cvt_pk_bf16_f32 v9, v9, v10
    v_cvt_pk_bf16_f32 v10, v8, 0
    v_cndmask_b32 v26, v26, v9, vcc
    v_cndmask_b32 v27, v27, v10, vcc
    v_mov_b32 v8, v15
    s_nop 1
    v_permlane32_swap_b32 v15, v8
    s_nop 1
    v_max3_f32 v15, v15, v8, v17
    v_add_f32 v13, v13, v15
    v_max_f32 v8, 0, v15
    v_exp_f32 v8, -v8
    v_sub_f32 v140, v140, v15
    v_sub_f32 v141, v141, v15
    v_sub_f32 v142, v142, v15
    v_sub_f32 v143, v143, v15
    v_sub_f32 v144, v144, v15
    v_sub_f32 v145, v145, v15
    v_sub_f32 v146, v146, v15
    v_sub_f32 v147, v147, v15
    v_sub_f32 v148, v148, v15
    v_sub_f32 v149, v149, v15
    v_sub_f32 v150, v150, v15
    v_sub_f32 v151, v151, v15
    v_sub_f32 v152, v152, v15
    v_sub_f32 v153, v153, v15
    v_sub_f32 v154, v154, v15
    v_sub_f32 v155, v155, v15
    v_mul_f32 v76, v76, v8
    v_mul_f32 v77, v77, v8
    v_mul_f32 v78, v78, v8
    v_mul_f32 v79, v79, v8
    v_mul_f32 v80, v80, v8
    v_mul_f32 v81, v81, v8
    v_mul_f32 v82, v82, v8
    v_mul_f32 v83, v83, v8
    v_mul_f32 v84, v84, v8
    v_mul_f32 v85, v85, v8
    v_mul_f32 v86, v86, v8
    v_mul_f32 v87, v87, v8
    v_mul_f32 v88, v88, v8
    v_mul_f32 v89, v89, v8
    v_mul_f32 v90, v90, v8
    v_mul_f32 v91, v91, v8
    v_sub_f32 v8, 0, v13
    v_cvt_pk_bf16_f32 v9, v8, v8
    v_and_b32 v9, 0xffff0000, v9
    v_sub_f32 v8, v8, v9
    v_cvt_pk_bf16_f32 v10, v8, v8
    v_and_b32 v10, 0xffff0000, v10
    v_sub_f32 v8, v8, v10
    v_cvt_pk_bf16_f32 v9, v9, v10
    v_cvt_pk_bf16_f32 v10, v8, 0
    v_cndmask_b32 v34, v34, v9, vcc
    v_cndmask_b32 v35, v35, v10, vcc
    v_mov_b32 v17, 0
    s_mov_b32 s67, 0x42000000
    s_branch A_ret1
A_slow0f:
    v_cmp_lt_u32 vcc, 31, v1
    v_mov_b32 v8, v14
    s_nop 1
    v_permlane32_swap_b32 v14, v8
    s_nop 1
    v_max3_f32 v14, v14, v8, v17
    v_add_f32 v12, v12, v14
    v_max_f32 v8, 0, v14
    v_exp_f32 v8, -v8
    v_sub_f32 v92, v92, v14
    v_sub_f32 v93, v93, v14
    v_sub_f32 v94, v94, v14
    v_sub_f32 v95, v95, v14
    v_sub_f32 v96, v96, v14
    v_sub_f32 v97, v97, v14
    v_sub_f32 v98, v98, v14
    v_sub_f32 v99, v99, v14
    v_sub_f32 v100, v100, v14
    v_sub_f32 v101, v101, v14
    v_sub_f32 v102, v102, v14
    v_sub_f32 v103, v103, v14
    v_sub_f32 v104, v104, v14
    v_sub_f32 v105, v105, v14
    v_sub_f32 v106, v106, v14
    v_sub_f32 v107, v107, v14
    v_mul_f32 v60, v60, v8
    v_mul_f32 v61, v61, v8
    v_mul_f32 v62, v62, v8
    v_mul_f32 v63, v63, v8
    v_mul_f32 v64, v64, v8
    v_mul_f32 v65, v65, v8
    v_mul_f32 v66, v66, v8
    v_mul_f32 v67, v67, v8
    v_mul_f32 v68, v68, v8
    v_mul_f32 v69, v69, v8
    v_mul_f32 v70, v70, v8
    v_mul_f32 v71, v71, v8
    v_mul_f32 v72, v72, v8
    v_mul_f32 v73, v73, v8
    v_mul_f32 v74, v74, v8
    v_mul_f32 v75, v75, v8
    v_sub_f32 v8, 0, v12
    v_cvt_pk_bf16_f32 v9, v8, v8
    v_and_b32 v9, 0xffff0000, v9
    v_sub_f32 v8, v8, v9
    v_cvt_pk_bf16_f32 v10, v8, v8
    v_and_b32 v10, 0xffff0000, v10
    v_sub_f32 v8, v8, v10
    v_cvt_pk_bf16_f32 v9, v9, v10
    v_cvt_pk_bf16_f32 v10, v8, 0
    v_cndmask_b32 v26, v26, v9, vcc
    v_cndmask_b32 v27, v27, v10, vcc
    v_mov_b32 v8, v15
    s_nop 1
    v_permlane32_swap_b32 v15, v8
    s_nop 1
    v_max3_f32 v15, v15, v8, v17
    v_add_f32 v13, v13, v15
    v_max_f32 v8, 0, v15
    v_exp_f32 v8, -v8
    v_sub_f32 v108, v108, v15
    v_sub_f32 v109, v109, v15
    v_sub_f32 v110, v110, v15
    v_sub_f32 v111, v111, v15
    v_sub_f32 v112, v112, v15
    v_sub_f32 v113, v113, v15
    v_sub_f32 v114, v114, v15
    v_sub_f32 v115, v115, v15
    v_sub_f32 v116, v116, v15
    v_sub_f32 v117, v117, v15
    v_sub_f32 v118, v118, v15
    v_sub_f32 v119, v119, v15
    v_sub_f32 v120, v120, v15
    v_sub_f32 v121, v121, v15
    v_sub_f32 v122, v122, v15
    v_sub_f32 v123, v123, v15
    v_mul_f32 v76, v76, v8
    v_mul_f32 v77, v77, v8
    v_mul_f32 v78, v78, v8
    v_mul_f32 v79, v79, v8
    v_mul_f32 v80, v80, v8
    v_mul_f32 v81, v81, v8
    v_mul_f32 v82, v82, v8
    v_mul_f32 v83, v83, v8
    v_mul_f32 v84, v84, v8
    v_mul_f32 v85, v85, v8
    v_mul_f32 v86, v86, v8
    v_mul_f32 v87, v87, v8
    v_mul_f32 v88, v88, v8
    v_mul_f32 v89, v89, v8
    v_mul_f32 v90, v90, v8
    v_mul_f32 v91, v91, v8
    v_sub_f32 v8, 0, v13
    v_cvt_pk_bf16_f32 v9, v8, v8
    v_and_b32 v9, 0xffff0000, v9
    v_sub_f32 v8, v8, v9
    v_cvt_pk_bf16_f32 v10, v8, v8
    v_and_b32 v10, 0xffff0000, v10
    v_sub_f32 v8, v8, v10
    v_cvt_pk_bf16_f32 v9, v9, v10
    v_cvt_pk_bf16_f32 v10, v8, 0
    v_cndmask_b32 v34, v34, v9, vcc
    v_cndmask_b32 v35, v35, v10, vcc
    v_mov_b32 v17, 0
    s_mov_b32 s67, 0x42000000
    s_branch A_ret0f
K23_mid:
    s_cmp_ge_u32 s2, 224
    s_cbranch_scc1 K3_exit
    v_and_b32 v1, 63, v0
    v_lshrrev_b32 v2, 5, v1
    v_and_b32 v3, 31, v1
    v_bfe_u32 v8, v1, 2, 2
    v_mul_u32_u24 v9, 4, v2
    v_add_u32 v8, v8, v9
    v_lshlrev_b32 v4, 6, v8
    v_bfe_u32 v8, v1, 4, 1
    v_lshlrev_b32 v8, 5, v8
    v_and_b32 v9, 3, v1
    v_lshlrev_b32 v9, 3, v9
    v_add3_u32 v4, v4, v8, v9
    v_lshrrev_b32 v8, 6, v0
    v_lshlrev_b32 v6, 4, v1
    v_readfirstlane_b32 s60, v8
    s_and_b32 s63, s2, 3
    s_lshl_b32 s63, s63, 2
    s_bfe_u32 s61, s2, 0x20003
    s_add_u32 s63, s63, s61
    s_bfe_u32 s64, s2, 0x10002
    s_mul_i32 s64, s64, 7
    s_lshr_b32 s61, s2, 5
    s_add_u32 s64, s64, s61
    s_mov_b32 s90, s63
    s_mov_b32 s91, s64
    s_lshr_b32 s75, s60, 2
    s_and_b32 s60, s60, 3
    s_lshl_b32 s63, s63, 2
    s_add_u32 s63, s63, s60
    s_cmp_lt_u32 s75, 2
    s_cbranch_scc1 K3_common
    s_mov_b32 s44, s28
    s_mov_b32 s45, s29
    s_mov_b32 s46, 1605632
    s_mov_b32 s47, 0x00020000
    s_lshl_b32 s65, s64, 8
    s_mul_i32 s61, s60, 57344
    s_add_u32 s65, s65, s61
    s_lshl_b32 s66, s60, 10
    s_add_u32 s66, s66, 114688
    v_lshrrev_b32 v8, 2, v1
    v_mul_u32_u24 v8, 3584, v8
    v_and_b32 v9, 3, v1
    v_lshlrev_b32 v9, 4, v9
    v_add_u32 v5, v8, v9
    s_mul_i32 s62, s63, 28672
    s_add_u32 s62, s62, 11534336
    s_mul_i32 s70, s60, 28672
    s_add_u32 m0, s66, 0
    s_add_u32 s61, s65, 0
    buffer_load_dwordx4 v5, s[44:47], s61 offen lds
    s_add_u32 m0, s66, 4096
    s_add_u32 s61, s65, 64
    buffer_load_dwordx4 v5, s[44:47], s61 offen lds
    s_add_u32 m0, s66, 8192
    s_add_u32 s61, s65, 229376
    buffer_load_dwordx4 v5, s[44:47], s61 offen lds
    s_add_u32 m0, s66, 12288
    s_add_u32 s61, s65, 229440
    buffer_load_dwordx4 v5, s[44:47], s61 offen lds
    s_add_u32 m0, s66, 16384
    s_add_u32 s61, s65, 458752
    buffer_load_dwordx4 v5, s[44:47], s61 offen lds
    s_add_u32 m0, s66, 20480
    s_add_u32 s61, s65, 458816
    buffer_load_dwordx4 v5, s[44:47], s61 offen lds
    s_add_u32 m0, s66, 24576
    s_add_u32 s61, s65, 688128
    buffer_load_dwordx4 v5, s[44:47], s61 offen lds
    s_add_u32 m0, s66, 28672
    s_add_u32 s61, s65, 688192
    buffer_load_dwordx4 v5, s[44:47], s61 offen lds
    s_add_u32 m0, s66, 32768
    s_add_u32 s61, s65, 917504
    buffer_load_dwordx4 v5, s[44:47], s61 offen lds
    s_add_u32 m0, s66, 36864
    s_add_u32 s61, s65, 917568
    buffer_load_dwordx4 v5, s[44:47], s61 offen lds
    s_mul_i32 s61, s90, 224
    s_add_u32 s61, s61, 24190976
    v_lshlrev_b32 v8, 2, v1
    v_add_u32 v9, s61, v8
    s_lshl_b32 s61, s91, 5
    s_add_u32 s61, s61, 24194848
    v_add_u32 v8, s61, v8
    v_cmp_lt_u32 vcc, 55, v1
    s_nop 1
    v_cndmask_b32 v9, v9, v8, vcc
    s_mov_b32 s72, 0
K3x1_poll:
    buffer_load_dword v10, v9, s[48:51], 0 offen sc1
    s_waitcnt vmcnt(0)
    v_cmp_ne_u32 vcc, s95, v10
    s_cbranch_vccz K3x1_ok
    s_sleep 3
    s_add_u32 s72, s72, 1
    s_cmp_lt_u32 s72, 0x80000
    s_cbranch_scc1 K3x1_poll
K3x1_ok:
    s_add_u32 m0, s70, 0
    s_add_u32 s61, s62, 0
    buffer_load_dwordx4 v6, s[48:51], s61 offen offset:0 sc1 lds
    buffer_load_dwordx4 v6, s[48:51], s61 offen offset:1024 sc1 lds
    buffer_load_dwordx4 v6, s[48:51], s61 offen offset:2048 sc1 lds
    buffer_load_dwordx4 v6, s[48:51], s61 offen offset:3072 sc1 lds
    s_add_u32 m0, s70, 4096
    s_add_u32 s61, s62, 4096
    buffer_load_dwordx4 v6, s[48:51], s61 offen offset:0 sc1 lds
    buffer_load_dwordx4 v6, s[48:51], s61 offen offset:1024 sc1 lds
    buffer_load_dwordx4 v6, s[48:51], s61 offen offset:2048 sc1 lds
    buffer_load_dwordx4 v6, s[48:51], s61 offen offset:3072 sc1 lds
    s_add_u32 m0, s70, 8192
    s_add_u32 s61, s62, 8192
    buffer_load_dwordx4 v6, s[48:51], s61 offen offset:0 sc1 lds
    buffer_load_dwordx4 v6, s[48:51], s61 offen offset:1024 sc1 lds
    buffer_load_dwordx4 v6, s[48:51], s61 offen offset:2048 sc1 lds
    buffer_load_dwordx4 v6, s[48:51], s61 offen offset:3072 sc1 lds
    s_add_u32 m0, s70, 12288
    s_add_u32 s61, s62, 12288
    buffer_load_dwordx4 v6, s[48:51], s61 offen offset:0 sc1 lds
    buffer_load_dwordx4 v6, s[48:51], s61 offen offset:1024 sc1 lds
    buffer_load_dwordx4 v6, s[48:51], s61 offen offset:2048 sc1 lds
    buffer_load_dwordx4 v6, s[48:51], s61 offen offset:3072 sc1 lds
    s_add_u32 m0, s70, 16384
    s_add_u32 s61, s62, 16384
    buffer_load_dwordx4 v6, s[48:51], s61 offen offset:0 sc1 lds
    buffer_load_dwordx4 v6, s[48:51], s61 offen offset:1024 sc1 lds
    buffer_load_dwordx4 v6, s[48:51], s61 offen offset:2048 sc1 lds
    buffer_load_dwordx4 v6, s[48:51], s61 offen offset:3072 sc1 lds
    s_add_u32 m0, s70, 20480
    s_add_u32 s61, s62, 20480
    buffer_load_dwordx4 v6, s[48:51], s61 offen offset:0 sc1 lds
    buffer_load_dwordx4 v6, s[48:51], s61 offen offset:1024 sc1 lds
    buffer_load_dwordx4 v6, s[48:51], s61 offen offset:2048 sc1 lds
    buffer_load_dwordx4 v6, s[48:51], s61 offen offset:3072 sc1 lds
    s_add_u32 m0, s70, 24576
    s_add_u32 s61, s62, 24576
    buffer_load_dwordx4 v6, s[48:51], s61 offen offset:0 sc1 lds
    buffer_load_dwordx4 v6, s[48:51], s61 offen offset:1024 sc1 lds
    buffer_load_dwordx4 v6, s[48:51], s61 offen offset:2048 sc1 lds
    buffer_load_dwordx4 v6, s[48:51], s61 offen offset:3072 sc1 lds
    s_lshl_b32 s61, s64, 9
    s_add_u32 s61, s61, 23068672
    s_mov_b32 m0, 155648
    s_nop 0
    buffer_load_dwordx4 v6, s[48:51], s61 offen sc1 lds
    s_waitcnt vmcnt(25)
    s_barrier
    s_waitcnt vmcnt(21)
    s_barrier
    s_waitcnt vmcnt(17)
    s_barrier
    s_add_u32 m0, s66, 0
    s_add_u32 s61, s65, 1146880
    buffer_load_dwordx4 v5, s[44:47], s61 offen lds
    s_add_u32 m0, s66, 4096
    s_add_u32 s61, s65, 1146944
    buffer_load_dwordx4 v5, s[44:47], s61 offen lds
    s_waitcnt vmcnt(15)
    s_barrier
    s_add_u32 m0, s66, 8192
    s_add_u32 s61, s65, 1376256
    buffer_load_dwordx4 v5, s[44:47], s61 offen lds
    s_add_u32 m0, s66, 12288
    s_add_u32 s61, s65, 1376320
    buffer_load_dwordx4 v5, s[44:47], s61 offen lds
    s_waitcnt vmcnt(13)
    s_barrier
    s_add_u32 m0, s66, 16384
    s_add_u32 s61, s65, 128
    buffer_load_dwordx4 v5, s[44:47], s61 offen lds
    s_add_u32 m0, s66, 20480
    s_add_u32 s61, s65, 192
    buffer_load_dwordx4 v5, s[44:47], s61 offen lds
    s_waitcnt vmcnt(4)
    s_barrier
    s_add_u32 m0, s66, 24576
    s_add_u32 s61, s65, 229504
    buffer_load_dwordx4 v5, s[44:47], s61 offen lds
    s_add_u32 m0, s66, 28672
    s_add_u32 s61, s65, 229568
    buffer_load_dwordx4 v5, s[44:47], s61 offen lds
    s_waitcnt vmcnt(4)
    s_barrier
    s_add_u32 m0, s66, 32768
    s_add_u32 s61, s65, 458880
    buffer_load_dwordx4 v5, s[44:47], s61 offen lds
    s_add_u32 m0, s66, 36864
    s_add_u32 s61, s65, 458944
    buffer_load_dwordx4 v5, s[44:47], s61 offen lds
    s_waitcnt vmcnt(4)
    s_barrier
    s_add_u32 m0, s66, 0
    s_add_u32 s61, s65, 688256
    buffer_load_dwordx4 v5, s[44:47], s61 offen lds
    s_add_u32 m0, s66, 4096
    s_add_u32 s61, s65, 688320
    buffer_load_dwordx4 v5, s[44:47], s61 offen lds
    s_waitcnt vmcnt(4)
    s_barrier
    s_add_u32 m0, s66, 8192
    s_add_u32 s61, s65, 917632
    buffer_load_dwordx4 v5, s[44:47], s61 offen lds
    s_add_u32 m0, s66, 12288
    s_add_u32 s61, s65, 917696
    buffer_load_dwordx4 v5, s[44:47], s61 offen lds
    s_waitcnt vmcnt(4)
    s_barrier
    s_add_u32 m0, s66, 16384
    s_add_u32 s61, s65, 1147008
    buffer_load_dwordx4 v5, s[44:47], s61 offen lds
    s_add_u32 m0, s66, 20480
    s_add_u32 s61, s65, 1147072
    buffer_load_dwordx4 v5, s[44:47], s61 offen lds
    s_waitcnt vmcnt(4)
    s_barrier
    s_add_u32 m0, s66, 24576
    s_add_u32 s61, s65, 1376384
    buffer_load_dwordx4 v5, s[44:47], s61 offen lds
    s_add_u32 m0, s66, 28672
    s_add_u32 s61, s65, 1376448
    buffer_load_dwordx4 v5, s[44:47], s61 offen lds
    s_waitcnt vmcnt(4)
    s_barrier
    s_waitcnt vmcnt(2)
    s_barrier
    s_waitcnt vmcnt(0)
    s_barrier
    s_barrier
    s_barrier
    s_branch K34_publish
K3_common:
    v_mov_b32 v8, 156672
    v_mov_b32 v9, 0
    ds_write_b32 v8, v9
    ds_write_b32 v8, v9 offset:4
    v_lshlrev_b32 v15, 4, v2
    s_lshl_b32 s61, s75, 8
    s_add_u32 s61, s61, 155648
    v_add_u32 v15, s61, v15
    s_mul_i32 s69, s63, 114688
    s_lshl_b32 s61, s64, 13
    s_add_u32 s69, s69, s61
    s_lshl_b32 s61, s75, 12
    s_add_u32 s69, s69, s61
    s_add_u32 s69, s69, 13631488
    s_mov_b32 s68, 3184710632
    v_mov_b32 v13, 3222493025
    s_mul_i32 s61, s60, 28672
    v_add_u32 v11, s61, v6
    v_add_u32 v4, 114688, v4
    s_mov_b32 s76, 0
    s_cmp_eq_u32 s75, 0
    s_cbranch_scc0 K3_B
    s_mov_b32 s71, 0
    s_barrier
    s_lshl_b32 s61, s63, 5
    v_add_u32 v8, s61, v3
    v_mul_u32_u24 v8, 112, v8
    s_mov_b32 s61, 22020096
    buffer_load_dwordx4 v[140:143], v8, s[48:51], s61 offen offset:0 sc1
    buffer_load_dwordx4 v[144:147], v8, s[48:51], s61 offen offset:16 sc1
    buffer_load_dwordx4 v[148:151], v8, s[48:51], s61 offen offset:32 sc1
    buffer_load_dwordx4 v[152:155], v8, s[48:51], s61 offen offset:48 sc1
    buffer_load_dwordx4 v[156:159], v8, s[48:51], s61 offen offset:64 sc1
    buffer_load_dwordx4 v[160:163], v8, s[48:51], s61 offen offset:80 sc1
    buffer_load_dwordx4 v[164:167], v8, s[48:51], s61 offen offset:96 sc1
    v_add_u32 v17, s76, v11
    v_add_u32 v7, s71, v4
    s_add_u32 s76, s76, 4096
    s_add_u32 s71, s71, 8192
    s_cmp_lt_u32 s71, 40960
    s_cselect_b32 s71, s71, 0
    v_mov_b32 v68, 0
    v_mov_b32 v69, 0
    v_mov_b32 v70, 0
    v_mov_b32 v71, 0
    v_mov_b32 v72, 0
    v_mov_b32 v73, 0
    v_mov_b32 v74, 0
    v_mov_b32 v75, 0
    v_mov_b32 v76, 0
    v_mov_b32 v77, 0
    v_mov_b32 v78, 0
    v_mov_b32 v79, 0
    v_mov_b32 v80, 0
    v_mov_b32 v81, 0
    v_mov_b32 v82, 0
    v_mov_b32 v83, 0
    v_mov_b32 v84, 0
    v_mov_b32 v85, 0
    v_mov_b32 v86, 0
    v_mov_b32 v87, 0
    v_mov_b32 v88, 0
    v_mov_b32 v89, 0
    v_mov_b32 v90, 0
    v_mov_b32 v91, 0
    v_mov_b32 v92, 0
    v_mov_b32 v93, 0
    v_mov_b32 v94, 0
    v_mov_b32 v95, 0
    v_mov_b32 v96, 0
    v_mov_b32 v97, 0
    v_mov_b32 v98, 0
    v_mov_b32 v99, 0
    ds_read_b128 v[20:23], v17 offset:0
    ds_read_b64_tr_b16 v[36:37], v7 offset:0
    ds_read_b64_tr_b16 v[38:39], v7 offset:512
    ds_read_b64_tr_b16 v[40:41], v7 offset:4096
    ds_read_b64_tr_b16 v[42:43], v7 offset:4608
    ds_read_b128 v[24:27], v17 offset:1024
    ds_read_b64_tr_b16 v[44:45], v7 offset:1024
    ds_read_b64_tr_b16 v[46:47], v7 offset:1536
    ds_read_b64_tr_b16 v[48:49], v7 offset:5120
    ds_read_b64_tr_b16 v[50:51], v7 offset:5632
    s_mov_b32 s72, 0
.p2align 6
K3A_loop:
    ds_read_b128 v[28:31], v17 offset:2048
    ds_read_b64_tr_b16 v[52:53], v7 offset:2048
    ds_read_b64_tr_b16 v[54:55], v7 offset:2560
    ds_read_b64_tr_b16 v[56:57], v7 offset:6144
    ds_read_b64_tr_b16 v[58:59], v7 offset:6656
    s_waitcnt lgkmcnt(10)
    v_mfma_f32_32x32x16_bf16 v[68:83], v[36:39], v[20:23], v[68:83]
    v_mfma_f32_32x32x16_bf16 v[84:99], v[40:43], v[20:23], v[84:99]
    ds_read_b128 v[32:35], v17 offset:3072
    ds_read_b64_tr_b16 v[60:61], v7 offset:3072
    ds_read_b64_tr_b16 v[62:63], v7 offset:3584
    ds_read_b64_tr_b16 v[64:65], v7 offset:7168
    ds_read_b64_tr_b16 v[66:67], v7 offset:7680
    s_waitcnt lgkmcnt(10)
    v_mfma_f32_32x32x16_bf16 v[68:83], v[44:47], v[24:27], v[68:83]
    v_mfma_f32_32x32x16_bf16 v[84:99], v[48:51], v[24:27], v[84:99]
    s_barrier
    v_add_u32 v17, s76, v11
    v_add_u32 v7, s71, v4
    s_add_u32 s76, s76, 4096
    s_add_u32 s71, s71, 8192
    s_cmp_lt_u32 s71, 40960
    s_cselect_b32 s71, s71, 0
    ds_read_b128 v[20:23], v17 offset:0
    ds_read_b64_tr_b16 v[36:37], v7 offset:0
    ds_read_b64_tr_b16 v[38:39], v7 offset:512
    ds_read_b64_tr_b16 v[40:41], v7 offset:4096
    ds_read_b64_tr_b16 v[42:43], v7 offset:4608
    s_waitcnt lgkmcnt(10)
    v_mfma_f32_32x32x16_bf16 v[68:83], v[52:55], v[28:31], v[68:83]
    v_mfma_f32_32x32x16_bf16 v[84:99], v[56:59], v[28:31], v[84:99]
    ds_read_b128 v[24:27], v17 offset:1024
    ds_read_b64_tr_b16 v[44:45], v7 offset:1024
    ds_read_b64_tr_b16 v[46:47], v7 offset:1536
    ds_read_b64_tr_b16 v[48:49], v7 offset:5120
    ds_read_b64_tr_b16 v[50:51], v7 offset:5632
    s_waitcnt lgkmcnt(10)
    v_mfma_f32_32x32x16_bf16 v[68:83], v[60:63], v[32:35], v[68:83]
    v_mfma_f32_32x32x16_bf16 v[84:99], v[64:67], v[32:35], v[84:99]
    s_add_u32 s72, s72, 1
    s_cmp_lt_u32 s72, 7
    s_cbranch_scc1 K3A_loop
    s_waitcnt lgkmcnt(0)
    s_waitcnt vmcnt(0)
    v_add_f32 v140, v140, v142
    v_add_f32 v141, v141, v143
    v_add_f32 v140, v140, v144
    v_add_f32 v141, v141, v145
    v_add_f32 v140, v140, v146
    v_add_f32 v141, v141, v147
    v_add_f32 v140, v140, v148
    v_add_f32 v141, v141, v149
    v_add_f32 v140, v140, v150
    v_add_f32 v141, v141, v151
    v_add_f32 v140, v140, v152
    v_add_f32 v141, v141, v153
    v_add_f32 v140, v140, v154
    v_add_f32 v141, v141, v155
    v_add_f32 v140, v140, v156
    v_add_f32 v141, v141, v157
    v_add_f32 v140, v140, v158
    v_add_f32 v141, v141, v159
    v_add_f32 v140, v140, v160
    v_add_f32 v141, v141, v161
    v_add_f32 v140, v140, v162
    v_add_f32 v141, v141, v163
    v_add_f32 v140, v140, v164
    v_add_f32 v141, v141, v165
    v_add_f32 v140, v140, v166
    v_add_f32 v141, v141, v167
    v_mul_f32 v12, 991054117, v140
    v_mul_f32 v14, 991054117, v141
    v_fma_f32 v14, -v12, v12, v14
    v_add_f32 v14, 925353388, v14
    v_rsq_f32 v14, v14
    ds_read_b128 v[124:127], v15 offset:0
    ds_read_b128 v[128:131], v15 offset:32
    ds_read_b128 v[132:135], v15 offset:64
    ds_read_b128 v[136:139], v15 offset:96
    s_waitcnt lgkmcnt(0)
    v_fma_f32 v68, -v12, v124, v68
    v_fma_f32 v69, -v12, v125, v69
    v_fma_f32 v70, -v12, v126, v70
    v_fma_f32 v71, -v12, v127, v71
    v_fma_f32 v72, -v12, v128, v72
    v_fma_f32 v73, -v12, v129, v73
    v_fma_f32 v74, -v12, v130, v74
    v_fma_f32 v75, -v12, v131, v75
    v_fma_f32 v76, -v12, v132, v76
    v_fma_f32 v77, -v12, v133, v77
    v_fma_f32 v78, -v12, v134, v78
    v_fma_f32 v79, -v12, v135, v79
    v_fma_f32 v80, -v12, v136, v80
    v_fma_f32 v81, -v12, v137, v81
    s_barrier
    v_fma_f32 v82, -v12, v138, v82
    v_fma_f32 v83, -v12, v139, v83
    v_mul_f32 v68, v14, v68
    v_mul_f32 v69, v14, v69
    v_mul_f32 v70, v14, v70
    v_mul_f32 v71, v14, v71
    v_mul_f32 v72, v14, v72
    v_mul_f32 v73, v14, v73
    v_mul_f32 v74, v14, v74
    v_mul_f32 v75, v14, v75
    v_mul_f32 v76, v14, v76
    v_mul_f32 v77, v14, v77
    v_mul_f32 v78, v14, v78
    v_mul_f32 v79, v14, v79
    v_mul_f32 v80, v14, v80
    v_mul_f32 v81, v14, v81
    v_mul_f32 v82, v14, v82
    v_mul_f32 v83, v14, v83
    v_mul_f32 v100, v68, v68
    v_mul_f32 v101, v69, v69
    v_mul_f32 v102, v70, v70
    v_mul_f32 v103, v71, v71
    v_mul_f32 v104, v72, v72
    v_mul_f32 v105, v73, v73
    v_mul_f32 v106, v74, v74
    v_mul_f32 v107, v75, v75
    v_mul_f32 v108, v76, v76
    v_mul_f32 v109, v77, v77
    v_mul_f32 v110, v78, v78
    v_mul_f32 v111, v79, v79
    v_mul_f32 v112, v80, v80
    v_mul_f32 v113, v81, v81
    v_mul_f32 v114, v82, v82
    v_mul_f32 v115, v83, v83
    v_fma_f32 v100, v100, s68, v13
    v_fma_f32 v101, v101, s68, v13
    v_fma_f32 v102, v102, s68, v13
    v_fma_f32 v103, v103, s68, v13
    v_fma_f32 v104, v104, s68, v13
    v_fma_f32 v105, v105, s68, v13
    v_fma_f32 v106, v106, s68, v13
    v_fma_f32 v107, v107, s68, v13
    v_fma_f32 v108, v108, s68, v13
    v_fma_f32 v109, v109, s68, v13
    v_fma_f32 v110, v110, s68, v13
    v_fma_f32 v111, v111, s68, v13
    v_fma_f32 v112, v112, s68, v13
    v_fma_f32 v113, v113, s68, v13
    v_fma_f32 v114, v114, s68, v13
    v_fma_f32 v115, v115, s68, v13
    v_mul_f32 v100, v100, v68
    s_barrier
    v_mul_f32 v101, v101, v69
    v_mul_f32 v102, v102, v70
    v_mul_f32 v103, v103, v71
    v_mul_f32 v104, v104, v72
    v_mul_f32 v105, v105, v73
    v_mul_f32 v106, v106, v74
    v_mul_f32 v107, v107, v75
    v_mul_f32 v108, v108, v76
    v_mul_f32 v109, v109, v77
    v_mul_f32 v110, v110, v78
    v_mul_f32 v111, v111, v79
    v_mul_f32 v112, v112, v80
    v_mul_f32 v113, v113, v81
    v_mul_f32 v114, v114, v82
    v_mul_f32 v115, v115, v83
    v_exp_f32 v100, v100
    v_exp_f32 v101, v101
    v_exp_f32 v102, v102
    v_exp_f32 v103, v103
    v_exp_f32 v104, v104
    v_exp_f32 v105, v105
    v_exp_f32 v106, v106
    v_exp_f32 v107, v107
    v_exp_f32 v108, v108
    v_exp_f32 v109, v109
    v_exp_f32 v110, v110
    v_exp_f32 v111, v111
    v_exp_f32 v112, v112
    v_exp_f32 v113, v113
    v_exp_f32 v114, v114
    v_exp_f32 v115, v115
    v_add_f32 v100, 1.0, v100
    v_add_f32 v101, 1.0, v101
    v_add_f32 v102, 1.0, v102
    v_add_f32 v103, 1.0, v103
    v_add_f32 v104, 1.0, v104
    v_add_f32 v105, 1.0, v105
    v_add_f32 v106, 1.0, v106
    v_add_f32 v107, 1.0, v107
    v_add_f32 v108, 1.0, v108
    v_add_f32 v109, 1.0, v109
    v_add_f32 v110, 1.0, v110
    v_add_f32 v111, 1.0, v111
    v_add_f32 v112, 1.0, v112
    v_add_f32 v113, 1.0, v113
    v_add_f32 v114, 1.0, v114
    v_add_f32 v115, 1.0, v115
    v_rcp_f32 v100, v100
    v_rcp_f32 v101, v101
    v_rcp_f32 v102, v102
    v_rcp_f32 v103, v103
    s_barrier
    v_rcp_f32 v104, v104
    v_rcp_f32 v105, v105
    v_rcp_f32 v106, v106
    v_rcp_f32 v107, v107
    v_rcp_f32 v108, v108
    v_rcp_f32 v109, v109
    v_rcp_f32 v110, v110
    v_rcp_f32 v111, v111
    v_rcp_f32 v112, v112
    v_rcp_f32 v113, v113
    v_rcp_f32 v114, v114
    v_rcp_f32 v115, v115
    v_mul_f32 v68, v68, v100
    v_mul_f32 v69, v69, v101
    v_mul_f32 v70, v70, v102
    v_mul_f32 v71, v71, v103
    v_mul_f32 v72, v72, v104
    v_mul_f32 v73, v73, v105
    v_mul_f32 v74, v74, v106
    v_mul_f32 v75, v75, v107
    v_mul_f32 v76, v76, v108
    v_mul_f32 v77, v77, v109
    v_mul_f32 v78, v78, v110
    v_mul_f32 v79, v79, v111
    v_mul_f32 v80, v80, v112
    v_mul_f32 v81, v81, v113
    v_mul_f32 v82, v82, v114
    v_mul_f32 v83, v83, v115
    v_cvt_pk_bf16_f32 v116, v68, v69
    v_cvt_pk_bf16_f32 v117, v70, v71
    v_cvt_pk_bf16_f32 v118, v72, v73
    v_cvt_pk_bf16_f32 v119, v74, v75
    v_cvt_pk_bf16_f32 v120, v76, v77
    v_cvt_pk_bf16_f32 v121, v78, v79
    v_cvt_pk_bf16_f32 v122, v80, v81
    v_cvt_pk_bf16_f32 v123, v82, v83
    buffer_store_dwordx4 v[116:119], v6, s[48:51], s69 offen offset:0 sc1
    buffer_store_dwordx4 v[120:123], v6, s[48:51], s69 offen offset:1024 sc1
    s_nop 1
    ds_read_b128 v[124:127], v15 offset:128
    ds_read_b128 v[128:131], v15 offset:160
    ds_read_b128 v[132:135], v15 offset:192
    ds_read_b128 v[136:139], v15 offset:224
    s_waitcnt lgkmcnt(0)
    v_fma_f32 v84, -v12, v124, v84
    v_fma_f32 v85, -v12, v125, v85
    v_fma_f32 v86, -v12, v126, v86
    v_fma_f32 v87, -v12, v127, v87
    v_fma_f32 v88, -v12, v128, v88
    v_fma_f32 v89, -v12, v129, v89
    v_fma_f32 v90, -v12, v130, v90
    s_barrier
    v_fma_f32 v91, -v12, v131, v91
    v_fma_f32 v92, -v12, v132, v92
    v_fma_f32 v93, -v12, v133, v93
    v_fma_f32 v94, -v12, v134, v94
    v_fma_f32 v95, -v12, v135, v95
    v_fma_f32 v96, -v12, v136, v96
    v_fma_f32 v97, -v12, v137, v97
    v_fma_f32 v98, -v12, v138, v98
    v_fma_f32 v99, -v12, v139, v99
    v_mul_f32 v84, v14, v84
    v_mul_f32 v85, v14, v85
    v_mul_f32 v86, v14, v86
    v_mul_f32 v87, v14, v87
    v_mul_f32 v88, v14, v88
    v_mul_f32 v89, v14, v89
    v_mul_f32 v90, v14, v90
    v_mul_f32 v91, v14, v91
    v_mul_f32 v92, v14, v92
    v_mul_f32 v93, v14, v93
    v_mul_f32 v94, v14, v94
    v_mul_f32 v95, v14, v95
    v_mul_f32 v96, v14, v96
    v_mul_f32 v97, v14, v97
    v_mul_f32 v98, v14, v98
    v_mul_f32 v99, v14, v99
    v_mul_f32 v100, v84, v84
    v_mul_f32 v101, v85, v85
    v_mul_f32 v102, v86, v86
    v_mul_f32 v103, v87, v87
    v_mul_f32 v104, v88, v88
    v_mul_f32 v105, v89, v89
    v_mul_f32 v106, v90, v90
    v_mul_f32 v107, v91, v91
    v_mul_f32 v108, v92, v92
    v_mul_f32 v109, v93, v93
    v_mul_f32 v110, v94, v94
    v_mul_f32 v111, v95, v95
    v_mul_f32 v112, v96, v96
    v_mul_f32 v113, v97, v97
    v_mul_f32 v114, v98, v98
    v_mul_f32 v115, v99, v99
    v_fma_f32 v100, v100, s68, v13
    v_fma_f32 v101, v101, s68, v13
    v_fma_f32 v102, v102, s68, v13
    v_fma_f32 v103, v103, s68, v13
    v_fma_f32 v104, v104, s68, v13
    v_fma_f32 v105, v105, s68, v13
    v_fma_f32 v106, v106, s68, v13
    v_fma_f32 v107, v107, s68, v13
    v_fma_f32 v108, v108, s68, v13
    v_fma_f32 v109, v109, s68, v13
    s_barrier
    v_fma_f32 v110, v110, s68, v13
    v_fma_f32 v111, v111, s68, v13
    v_fma_f32 v112, v112, s68, v13
    v_fma_f32 v113, v113, s68, v13
    v_fma_f32 v114, v114, s68, v13
    v_fma_f32 v115, v115, s68, v13
    v_mul_f32 v100, v100, v84
    v_mul_f32 v101, v101, v85
    v_mul_f32 v102, v102, v86
    v_mul_f32 v103, v103, v87
    v_mul_f32 v104, v104, v88
    v_mul_f32 v105, v105, v89
    v_mul_f32 v106, v106, v90
    v_mul_f32 v107, v107, v91
    v_mul_f32 v108, v108, v92
    v_mul_f32 v109, v109, v93
    v_mul_f32 v110, v110, v94
    v_mul_f32 v111, v111, v95
    v_mul_f32 v112, v112, v96
    v_mul_f32 v113, v113, v97
    v_mul_f32 v114, v114, v98
    v_mul_f32 v115, v115, v99
    v_exp_f32 v100, v100
    v_exp_f32 v101, v101
    v_exp_f32 v102, v102
    v_exp_f32 v103, v103
    v_exp_f32 v104, v104
    v_exp_f32 v105, v105
    v_exp_f32 v106, v106
    v_exp_f32 v107, v107
    v_exp_f32 v108, v108
    v_exp_f32 v109, v109
    v_exp_f32 v110, v110
    v_exp_f32 v111, v111
    v_exp_f32 v112, v112
    v_exp_f32 v113, v113
    v_exp_f32 v114, v114
    v_exp_f32 v115, v115
    v_add_f32 v100, 1.0, v100
    v_add_f32 v101, 1.0, v101
    v_add_f32 v102, 1.0, v102
    v_add_f32 v103, 1.0, v103
    v_add_f32 v104, 1.0, v104
    v_add_f32 v105, 1.0, v105
    v_add_f32 v106, 1.0, v106
    v_add_f32 v107, 1.0, v107
    v_add_f32 v108, 1.0, v108
    v_add_f32 v109, 1.0, v109
    v_add_f32 v110, 1.0, v110
    v_add_f32 v111, 1.0, v111
    v_add_f32 v112, 1.0, v112
    s_barrier
    v_add_f32 v113, 1.0, v113
    v_add_f32 v114, 1.0, v114
    v_add_f32 v115, 1.0, v115
    v_rcp_f32 v100, v100
    v_rcp_f32 v101, v101
    v_rcp_f32 v102, v102
    v_rcp_f32 v103, v103
    v_rcp_f32 v104, v104
    v_rcp_f32 v105, v105
    v_rcp_f32 v106, v106
    v_rcp_f32 v107, v107
    v_rcp_f32 v108, v108
    v_rcp_f32 v109, v109
    v_rcp_f32 v110, v110
    v_rcp_f32 v111, v111
    v_rcp_f32 v112, v112
    v_rcp_f32 v113, v113
    v_rcp_f32 v114, v114
    v_rcp_f32 v115, v115
    v_mul_f32 v84, v84, v100
    v_mul_f32 v85, v85, v101
    v_mul_f32 v86, v86, v102
    v_mul_f32 v87, v87, v103
    v_mul_f32 v88, v88, v104
    v_mul_f32 v89, v89, v105
    v_mul_f32 v90, v90, v106
    v_mul_f32 v91, v91, v107
    v_mul_f32 v92, v92, v108
    v_mul_f32 v93, v93, v109
    v_mul_f32 v94, v94, v110
    v_mul_f32 v95, v95, v111
    v_mul_f32 v96, v96, v112
    v_mul_f32 v97, v97, v113
    v_mul_f32 v98, v98, v114
    v_mul_f32 v99, v99, v115
    v_cvt_pk_bf16_f32 v116, v84, v85
    v_cvt_pk_bf16_f32 v117, v86, v87
    v_cvt_pk_bf16_f32 v118, v88, v89
    v_cvt_pk_bf16_f32 v119, v90, v91
    v_cvt_pk_bf16_f32 v120, v92, v93
    v_cvt_pk_bf16_f32 v121, v94, v95
    v_cvt_pk_bf16_f32 v122, v96, v97
    v_cvt_pk_bf16_f32 v123, v98, v99
    buffer_store_dwordx4 v[116:119], v6, s[48:51], s69 offen offset:2048 sc1
    buffer_store_dwordx4 v[120:123], v6, s[48:51], s69 offen offset:3072 sc1
    s_nop 1
    s_barrier
    s_barrier
    s_branch K34_publish
K3_B:
    s_barrier
    s_lshl_b32 s61, s63, 5
    v_add_u32 v8, s61, v3
    v_mul_u32_u24 v8, 112, v8
    s_mov_b32 s61, 22020096
    buffer_load_dwordx4 v[140:143], v8, s[48:51], s61 offen offset:0 sc1
    buffer_load_dwordx4 v[144:147], v8, s[48:51], s61 offen offset:16 sc1
    buffer_load_dwordx4 v[148:151], v8, s[48:51], s61 offen offset:32 sc1
    buffer_load_dwordx4 v[152:155], v8, s[48:51], s61 offen offset:48 sc1
    buffer_load_dwordx4 v[156:159], v8, s[48:51], s61 offen offset:64 sc1
    buffer_load_dwordx4 v[160:163], v8, s[48:51], s61 offen offset:80 sc1
    buffer_load_dwordx4 v[164:167], v8, s[48:51], s61 offen offset:96 sc1
    s_barrier
    s_barrier
    s_barrier
    s_barrier
    s_barrier
    s_barrier
    s_barrier
    s_mov_b32 s71, 16384
    v_add_u32 v17, s76, v11
    v_add_u32 v7, s71, v4
    s_add_u32 s76, s76, 4096
    s_add_u32 s71, s71, 8192
    s_cmp_lt_u32 s71, 40960
    s_cselect_b32 s71, s71, 0
    v_mov_b32 v68, 0
    v_mov_b32 v69, 0
    v_mov_b32 v70, 0
    v_mov_b32 v71, 0
    v_mov_b32 v72, 0
    v_mov_b32 v73, 0
    v_mov_b32 v74, 0
    v_mov_b32 v75, 0
    v_mov_b32 v76, 0
    v_mov_b32 v77, 0
    v_mov_b32 v78, 0
    v_mov_b32 v79, 0
    v_mov_b32 v80, 0
    v_mov_b32 v81, 0
    v_mov_b32 v82, 0
    v_mov_b32 v83, 0
    v_mov_b32 v84, 0
    v_mov_b32 v85, 0
    v_mov_b32 v86, 0
    v_mov_b32 v87, 0
    v_mov_b32 v88, 0
    v_mov_b32 v89, 0
    v_mov_b32 v90, 0
    v_mov_b32 v91, 0
    v_mov_b32 v92, 0
    v_mov_b32 v93, 0
    v_mov_b32 v94, 0
    v_mov_b32 v95, 0
    v_mov_b32 v96, 0
    v_mov_b32 v97, 0
    v_mov_b32 v98, 0
    v_mov_b32 v99, 0
    ds_read_b128 v[20:23], v17 offset:0
    ds_read_b64_tr_b16 v[36:37], v7 offset:0
    ds_read_b64_tr_b16 v[38:39], v7 offset:512
    ds_read_b64_tr_b16 v[40:41], v7 offset:4096
    ds_read_b64_tr_b16 v[42:43], v7 offset:4608
    ds_read_b128 v[24:27], v17 offset:1024
    ds_read_b64_tr_b16 v[44:45], v7 offset:1024
    ds_read_b64_tr_b16 v[46:47], v7 offset:1536
    ds_read_b64_tr_b16 v[48:49], v7 offset:5120
    ds_read_b64_tr_b16 v[50:51], v7 offset:5632
    s_mov_b32 s72, 0
.p2align 6
K3B_loop:
    ds_read_b128 v[28:31], v17 offset:2048
    ds_read_b64_tr_b16 v[52:53], v7 offset:2048
    ds_read_b64_tr_b16 v[54:55], v7 offset:2560
    ds_read_b64_tr_b16 v[56:57], v7 offset:6144
    ds_read_b64_tr_b16 v[58:59], v7 offset:6656
    s_waitcnt lgkmcnt(10)
    v_mfma_f32_32x32x16_bf16 v[68:83], v[36:39], v[20:23], v[68:83]
    v_mfma_f32_32x32x16_bf16 v[84:99], v[40:43], v[20:23], v[84:99]
    ds_read_b128 v[32:35], v17 offset:3072
    ds_read_b64_tr_b16 v[60:61], v7 offset:3072
    ds_read_b64_tr_b16 v[62:63], v7 offset:3584
    ds_read_b64_tr_b16 v[64:65], v7 offset:7168
    ds_read_b64_tr_b16 v[66:67], v7 offset:7680
    s_waitcnt lgkmcnt(10)
    v_mfma_f32_32x32x16_bf16 v[68:83], v[44:47], v[24:27], v[68:83]
    v_mfma_f32_32x32x16_bf16 v[84:99], v[48:51], v[24:27], v[84:99]
    s_barrier
    v_add_u32 v17, s76, v11
    v_add_u32 v7, s71, v4
    s_add_u32 s76, s76, 4096
    s_add_u32 s71, s71, 8192
    s_cmp_lt_u32 s71, 40960
    s_cselect_b32 s71, s71, 0
    ds_read_b128 v[20:23], v17 offset:0
    ds_read_b64_tr_b16 v[36:37], v7 offset:0
    ds_read_b64_tr_b16 v[38:39], v7 offset:512
    ds_read_b64_tr_b16 v[40:41], v7 offset:4096
    ds_read_b64_tr_b16 v[42:43], v7 offset:4608
    s_waitcnt lgkmcnt(10)
    v_mfma_f32_32x32x16_bf16 v[68:83], v[52:55], v[28:31], v[68:83]
    v_mfma_f32_32x32x16_bf16 v[84:99], v[56:59], v[28:31], v[84:99]
    ds_read_b128 v[24:27], v17 offset:1024
    ds_read_b64_tr_b16 v[44:45], v7 offset:1024
    ds_read_b64_tr_b16 v[46:47], v7 offset:1536
    ds_read_b64_tr_b16 v[48:49], v7 offset:5120
    ds_read_b64_tr_b16 v[50:51], v7 offset:5632
    s_waitcnt lgkmcnt(10)
    v_mfma_f32_32x32x16_bf16 v[68:83], v[60:63], v[32:35], v[68:83]
    v_mfma_f32_32x32x16_bf16 v[84:99], v[64:67], v[32:35], v[84:99]
    s_add_u32 s72, s72, 1
    s_cmp_lt_u32 s72, 7
    s_cbranch_scc1 K3B_loop
    s_waitcnt lgkmcnt(0)
    s_barrier
    s_nop 10
    s_waitcnt vmcnt(0)
    v_add_f32 v140, v140, v142
    v_add_f32 v141, v141, v143
    v_add_f32 v140, v140, v144
    v_add_f32 v141, v141, v145
    v_add_f32 v140, v140, v146
    v_add_f32 v141, v141, v147
    v_add_f32 v140, v140, v148
    v_add_f32 v141, v141, v149
    v_add_f32 v140, v140, v150
    v_add_f32 v141, v141, v151
    v_add_f32 v140, v140, v152
    v_add_f32 v141, v141, v153
    v_add_f32 v140, v140, v154
    v_add_f32 v141, v141, v155
    v_add_f32 v140, v140, v156
    v_add_f32 v141, v141, v157
    v_add_f32 v140, v140, v158
    v_add_f32 v141, v141, v159
    v_add_f32 v140, v140, v160
    v_add_f32 v141, v141, v161
    v_add_f32 v140, v140, v162
    v_add_f32 v141, v141, v163
    v_add_f32 v140, v140, v164
    v_add_f32 v141, v141, v165
    v_add_f32 v140, v140, v166
    v_add_f32 v141, v141, v167
    v_mul_f32 v12, 991054117, v140
    v_mul_f32 v14, 991054117, v141
    v_fma_f32 v14, -v12, v12, v14
    v_add_f32 v14, 925353388, v14
    v_rsq_f32 v14, v14
    ds_read_b128 v[124:127], v15 offset:0
    ds_read_b128 v[128:131], v15 offset:32
    ds_read_b128 v[132:135], v15 offset:64
    ds_read_b128 v[136:139], v15 offset:96
    s_waitcnt lgkmcnt(0)
    v_fma_f32 v68, -v12, v124, v68
    v_fma_f32 v69, -v12, v125, v69
    v_fma_f32 v70, -v12, v126, v70
    v_fma_f32 v71, -v12, v127, v71
    v_fma_f32 v72, -v12, v128, v72
    v_fma_f32 v73, -v12, v129, v73
    v_fma_f32 v74, -v12, v130, v74
    v_fma_f32 v75, -v12, v131, v75
    v_fma_f32 v76, -v12, v132, v76
    v_fma_f32 v77, -v12, v133, v77
    v_fma_f32 v78, -v12, v134, v78
    v_fma_f32 v79, -v12, v135, v79
    v_fma_f32 v80, -v12, v136, v80
    v_fma_f32 v81, -v12, v137, v81
    v_fma_f32 v82, -v12, v138, v82
    v_fma_f32 v83, -v12, v139, v83
    v_mul_f32 v68, v14, v68
    v_mul_f32 v69, v14, v69
    v_mul_f32 v70, v14, v70
    v_mul_f32 v71, v14, v71
    v_mul_f32 v72, v14, v72
    v_mul_f32 v73, v14, v73
    v_mul_f32 v74, v14, v74
    v_mul_f32 v75, v14, v75
    v_mul_f32 v76, v14, v76
    v_mul_f32 v77, v14, v77
    v_mul_f32 v78, v14, v78
    v_mul_f32 v79, v14, v79
    v_mul_f32 v80, v14, v80
    v_mul_f32 v81, v14, v81
    v_mul_f32 v82, v14, v82
    v_mul_f32 v83, v14, v83
    v_mul_f32 v100, v68, v68
    v_mul_f32 v101, v69, v69
    v_mul_f32 v102, v70, v70
    v_mul_f32 v103, v71, v71
    v_mul_f32 v104, v72, v72
    v_mul_f32 v105, v73, v73
    v_mul_f32 v106, v74, v74
    v_mul_f32 v107, v75, v75
    v_mul_f32 v108, v76, v76
    v_mul_f32 v109, v77, v77
    v_mul_f32 v110, v78, v78
    v_mul_f32 v111, v79, v79
    v_mul_f32 v112, v80, v80
    v_mul_f32 v113, v81, v81
    v_mul_f32 v114, v82, v82
    v_mul_f32 v115, v83, v83
    v_fma_f32 v100, v100, s68, v13
    v_fma_f32 v101, v101, s68, v13
    v_fma_f32 v102, v102, s68, v13
    v_fma_f32 v103, v103, s68, v13
    v_fma_f32 v104, v104, s68, v13
    v_fma_f32 v105, v105, s68, v13
    v_fma_f32 v106, v106, s68, v13
    v_fma_f32 v107, v107, s68, v13
    v_fma_f32 v108, v108, s68, v13
    v_fma_f32 v109, v109, s68, v13
    v_fma_f32 v110, v110, s68, v13
    v_fma_f32 v111, v111, s68, v13
    v_fma_f32 v112, v112, s68, v13
    v_fma_f32 v113, v113, s68, v13
    v_fma_f32 v114, v114, s68, v13
    v_fma_f32 v115, v115, s68, v13
    v_mul_f32 v100, v100, v68
    v_mul_f32 v101, v101, v69
    v_mul_f32 v102, v102, v70
    v_mul_f32 v103, v103, v71
    v_mul_f32 v104, v104, v72
    v_mul_f32 v105, v105, v73
    v_mul_f32 v106, v106, v74
    v_mul_f32 v107, v107, v75
    v_mul_f32 v108, v108, v76
    v_mul_f32 v109, v109, v77
    v_mul_f32 v110, v110, v78
    v_mul_f32 v111, v111, v79
    v_mul_f32 v112, v112, v80
    v_mul_f32 v113, v113, v81
    v_mul_f32 v114, v114, v82
    v_mul_f32 v115, v115, v83
    v_exp_f32 v100, v100
    v_exp_f32 v101, v101
    v_exp_f32 v102, v102
    v_exp_f32 v103, v103
    v_exp_f32 v104, v104
    v_exp_f32 v105, v105
    v_exp_f32 v106, v106
    v_exp_f32 v107, v107
    v_exp_f32 v108, v108
    v_exp_f32 v109, v109
    v_exp_f32 v110, v110
    v_exp_f32 v111, v111
    v_exp_f32 v112, v112
    v_exp_f32 v113, v113
    v_exp_f32 v114, v114
    v_exp_f32 v115, v115
    v_add_f32 v100, 1.0, v100
    v_add_f32 v101, 1.0, v101
    v_add_f32 v102, 1.0, v102
    v_add_f32 v103, 1.0, v103
    v_add_f32 v104, 1.0, v104
    v_add_f32 v105, 1.0, v105
    v_add_f32 v106, 1.0, v106
    v_add_f32 v107, 1.0, v107
    v_add_f32 v108, 1.0, v108
    v_add_f32 v109, 1.0, v109
    v_add_f32 v110, 1.0, v110
    v_add_f32 v111, 1.0, v111
    v_add_f32 v112, 1.0, v112
    v_add_f32 v113, 1.0, v113
    v_add_f32 v114, 1.0, v114
    v_add_f32 v115, 1.0, v115
    v_rcp_f32 v100, v100
    v_rcp_f32 v101, v101
    v_rcp_f32 v102, v102
    v_rcp_f32 v103, v103
    v_rcp_f32 v104, v104
    v_rcp_f32 v105, v105
    v_rcp_f32 v106, v106
    v_rcp_f32 v107, v107
    v_rcp_f32 v108, v108
    v_rcp_f32 v109, v109
    v_rcp_f32 v110, v110
    v_rcp_f32 v111, v111
    v_rcp_f32 v112, v112
    v_rcp_f32 v113, v113
    v_rcp_f32 v114, v114
    v_rcp_f32 v115, v115
    v_mul_f32 v68, v68, v100
    v_mul_f32 v69, v69, v101
    v_mul_f32 v70, v70, v102
    v_mul_f32 v71, v71, v103
    v_mul_f32 v72, v72, v104
    v_mul_f32 v73, v73, v105
    v_mul_f32 v74, v74, v106
    v_mul_f32 v75, v75, v107
    v_mul_f32 v76, v76, v108
    v_mul_f32 v77, v77, v109
    v_mul_f32 v78, v78, v110
    v_mul_f32 v79, v79, v111
    v_mul_f32 v80, v80, v112
    v_mul_f32 v81, v81, v113
    v_mul_f32 v82, v82, v114
    v_mul_f32 v83, v83, v115
    v_cvt_pk_bf16_f32 v116, v68, v69
    v_cvt_pk_bf16_f32 v117, v70, v71
    v_cvt_pk_bf16_f32 v118, v72, v73
    v_cvt_pk_bf16_f32 v119, v74, v75
    v_cvt_pk_bf16_f32 v120, v76, v77
    v_cvt_pk_bf16_f32 v121, v78, v79
    v_cvt_pk_bf16_f32 v122, v80, v81
    v_cvt_pk_bf16_f32 v123, v82, v83
    buffer_store_dwordx4 v[116:119], v6, s[48:51], s69 offen offset:0 sc1
    buffer_store_dwordx4 v[120:123], v6, s[48:51], s69 offen offset:1024 sc1
    s_nop 1
    ds_read_b128 v[124:127], v15 offset:128
    ds_read_b128 v[128:131], v15 offset:160
    ds_read_b128 v[132:135], v15 offset:192
    ds_read_b128 v[136:139], v15 offset:224
    s_waitcnt lgkmcnt(0)
    v_fma_f32 v84, -v12, v124, v84
    v_fma_f32 v85, -v12, v125, v85
    v_fma_f32 v86, -v12, v126, v86
    v_fma_f32 v87, -v12, v127, v87
    v_fma_f32 v88, -v12, v128, v88
    v_fma_f32 v89, -v12, v129, v89
    v_fma_f32 v90, -v12, v130, v90
    v_fma_f32 v91, -v12, v131, v91
    v_fma_f32 v92, -v12, v132, v92
    v_fma_f32 v93, -v12, v133, v93
    v_fma_f32 v94, -v12, v134, v94
    v_fma_f32 v95, -v12, v135, v95
    v_fma_f32 v96, -v12, v136, v96
    v_fma_f32 v97, -v12, v137, v97
    v_fma_f32 v98, -v12, v138, v98
    v_fma_f32 v99, -v12, v139, v99
    v_mul_f32 v84, v14, v84
    v_mul_f32 v85, v14, v85
    v_mul_f32 v86, v14, v86
    v_mul_f32 v87, v14, v87
    v_mul_f32 v88, v14, v88
    v_mul_f32 v89, v14, v89
    v_mul_f32 v90, v14, v90
    v_mul_f32 v91, v14, v91
    v_mul_f32 v92, v14, v92
    v_mul_f32 v93, v14, v93
    v_mul_f32 v94, v14, v94
    v_mul_f32 v95, v14, v95
    v_mul_f32 v96, v14, v96
    v_mul_f32 v97, v14, v97
    v_mul_f32 v98, v14, v98
    v_mul_f32 v99, v14, v99
    v_mul_f32 v100, v84, v84
    v_mul_f32 v101, v85, v85
    v_mul_f32 v102, v86, v86
    v_mul_f32 v103, v87, v87
    v_mul_f32 v104, v88, v88
    v_mul_f32 v105, v89, v89
    v_mul_f32 v106, v90, v90
    v_mul_f32 v107, v91, v91
    v_mul_f32 v108, v92, v92
    v_mul_f32 v109, v93, v93
    v_mul_f32 v110, v94, v94
    v_mul_f32 v111, v95, v95
    v_mul_f32 v112, v96, v96
    v_mul_f32 v113, v97, v97
    v_mul_f32 v114, v98, v98
    v_mul_f32 v115, v99, v99
    v_fma_f32 v100, v100, s68, v13
    v_fma_f32 v101, v101, s68, v13
    v_fma_f32 v102, v102, s68, v13
    v_fma_f32 v103, v103, s68, v13
    v_fma_f32 v104, v104, s68, v13
    v_fma_f32 v105, v105, s68, v13
    v_fma_f32 v106, v106, s68, v13
    v_fma_f32 v107, v107, s68, v13
    v_fma_f32 v108, v108, s68, v13
    v_fma_f32 v109, v109, s68, v13
    v_fma_f32 v110, v110, s68, v13
    v_fma_f32 v111, v111, s68, v13
    v_fma_f32 v112, v112, s68, v13
    v_fma_f32 v113, v113, s68, v13
    v_fma_f32 v114, v114, s68, v13
    v_fma_f32 v115, v115, s68, v13
    v_mul_f32 v100, v100, v84
    v_mul_f32 v101, v101, v85
    v_mul_f32 v102, v102, v86
    v_mul_f32 v103, v103, v87
    v_mul_f32 v104, v104, v88
    v_mul_f32 v105, v105, v89
    v_mul_f32 v106, v106, v90
    v_mul_f32 v107, v107, v91
    v_mul_f32 v108, v108, v92
    v_mul_f32 v109, v109, v93
    v_mul_f32 v110, v110, v94
    v_mul_f32 v111, v111, v95
    v_mul_f32 v112, v112, v96
    v_mul_f32 v113, v113, v97
    v_mul_f32 v114, v114, v98
    v_mul_f32 v115, v115, v99
    v_exp_f32 v100, v100
    v_exp_f32 v101, v101
    v_exp_f32 v102, v102
    v_exp_f32 v103, v103
    v_exp_f32 v104, v104
    v_exp_f32 v105, v105
    v_exp_f32 v106, v106
    v_exp_f32 v107, v107
    v_exp_f32 v108, v108
    v_exp_f32 v109, v109
    v_exp_f32 v110, v110
    v_exp_f32 v111, v111
    v_exp_f32 v112, v112
    v_exp_f32 v113, v113
    v_exp_f32 v114, v114
    v_exp_f32 v115, v115
    v_add_f32 v100, 1.0, v100
    v_add_f32 v101, 1.0, v101
    v_add_f32 v102, 1.0, v102
    v_add_f32 v103, 1.0, v103
    v_add_f32 v104, 1.0, v104
    v_add_f32 v105, 1.0, v105
    v_add_f32 v106, 1.0, v106
    v_add_f32 v107, 1.0, v107
    v_add_f32 v108, 1.0, v108
    v_add_f32 v109, 1.0, v109
    v_add_f32 v110, 1.0, v110
    v_add_f32 v111, 1.0, v111
    v_add_f32 v112, 1.0, v112
    v_add_f32 v113, 1.0, v113
    v_add_f32 v114, 1.0, v114
    v_add_f32 v115, 1.0, v115
    v_rcp_f32 v100, v100
    v_rcp_f32 v101, v101
    v_rcp_f32 v102, v102
    v_rcp_f32 v103, v103
    v_rcp_f32 v104, v104
    v_rcp_f32 v105, v105
    v_rcp_f32 v106, v106
    v_rcp_f32 v107, v107
    v_rcp_f32 v108, v108
    v_rcp_f32 v109, v109
    v_rcp_f32 v110, v110
    v_rcp_f32 v111, v111
    v_rcp_f32 v112, v112
    v_rcp_f32 v113, v113
    v_rcp_f32 v114, v114
    v_rcp_f32 v115, v115
    v_mul_f32 v84, v84, v100
    v_mul_f32 v85, v85, v101
    v_mul_f32 v86, v86, v102
    v_mul_f32 v87, v87, v103
    v_mul_f32 v88, v88, v104
    v_mul_f32 v89, v89, v105
    v_mul_f32 v90, v90, v106
    v_mul_f32 v91, v91, v107
    v_mul_f32 v92, v92, v108
    v_mul_f32 v93, v93, v109
    v_mul_f32 v94, v94, v110
    v_mul_f32 v95, v95, v111
    v_mul_f32 v96, v96, v112
    v_mul_f32 v97, v97, v113
    v_mul_f32 v98, v98, v114
    v_mul_f32 v99, v99, v115
    v_cvt_pk_bf16_f32 v116, v84, v85
    v_cvt_pk_bf16_f32 v117, v86, v87
    v_cvt_pk_bf16_f32 v118, v88, v89
    v_cvt_pk_bf16_f32 v119, v90, v91
    v_cvt_pk_bf16_f32 v120, v92, v93
    v_cvt_pk_bf16_f32 v121, v94, v95
    v_cvt_pk_bf16_f32 v122, v96, v97
    v_cvt_pk_bf16_f32 v123, v98, v99
    buffer_store_dwordx4 v[116:119], v6, s[48:51], s69 offen offset:2048 sc1
    buffer_store_dwordx4 v[120:123], v6, s[48:51], s69 offen offset:3072 sc1
    s_nop 1
K34_publish:
    v_and_b32 v1, 63, v0
    v_lshrrev_b32 v2, 5, v1
    v_and_b32 v3, 31, v1
    v_bfe_u32 v10, v1, 2, 2
    v_mul_u32_u24 v11, 4, v2
    v_add_u32 v10, v10, v11
    v_lshlrev_b32 v4, 6, v10
    v_bfe_u32 v10, v1, 4, 1
    v_lshlrev_b32 v10, 5, v10
    v_and_b32 v11, 3, v1
    v_lshlrev_b32 v11, 3, v11
    v_add3_u32 v4, v4, v10, v11
    s_and_b32 s63, s2, 31
    s_lshr_b32 s64, s2, 5
    s_cmp_lt_u32 s75, 2
    s_cbranch_scc1 K4_pub
    s_mov_b32 s44, s30
    s_mov_b32 s45, s31
    s_mov_b32 s46, 1605632
    s_mov_b32 s47, 0x00020000
    s_mov_b32 s52, s20
    s_mov_b32 s53, s21
    s_mov_b32 s54, 401408
    s_mov_b32 s55, 0x00020000
    s_lshr_b32 s69, s63, 1
    s_lshl_b32 s69, s69, 8
    s_add_u32 s69, s69, 24117248
    s_and_b32 s61, s60, 1
    s_lshr_b32 s62, s60, 1
    s_lshl_b32 s70, s61, 13
    s_lshl_b32 s71, s62, 12
    s_add_u32 s70, s70, s71
    s_add_u32 s71, s70, 16384
    s_lshl_b32 s65, s63, 1
    s_add_u32 s65, s65, s61
    s_lshl_b32 s72, s65, 15
    s_mul_i32 s65, s65, 114688
    s_lshl_b32 s66, s62, 12
    s_add_u32 s65, s65, s66
    s_add_u32 s72, s72, s66
    s_add_u32 s65, s65, 13631488
    s_add_u32 s72, s72, 9437184
    s_lshl_b32 s66, s64, 1
    s_add_u32 s66, s66, s61
    s_lshl_b32 s66, s66, 6
    s_mul_i32 s73, s62, 50176
    s_add_u32 s73, s73, s66
    s_mul_i32 s62, s62, 57344
    s_add_u32 s66, s66, s62
    v_lshrrev_b32 v10, 2, v1
    v_mul_u32_u24 v10, 896, v10
    v_and_b32 v11, 3, v1
    v_lshlrev_b32 v11, 4, v11
    v_add_u32 v5, v10, v11
    s_mov_b32 s74, 0
    s_mov_b32 s76, 0
    v_mov_b32 v12, 0
    s_lshr_b32 s61, s63, 1
    s_lshl_b32 s61, s61, 8
    s_add_u32 s61, s61, 24199168
    v_lshlrev_b32 v10, 2, v1
    v_add_u32 v11, s61, v10
    s_mov_b32 s77, 0
K4o_poll:
    buffer_load_dword v12, v11, s[48:51], 0 offen sc1
    s_waitcnt vmcnt(0)
    v_cmp_ne_u32 vcc, s95, v12
    s_cbranch_vccz K4o_ok
    s_sleep 3
    s_add_u32 s77, s77, 1
    s_cmp_lt_u32 s77, 0x80000
    s_cbranch_scc1 K4o_poll
K4o_ok:
    v_mov_b32 v12, 0
    s_mov_b32 s67, 0
    s_add_u32 s62, s71, s67
    s_add_u32 m0, s62, 0
    s_add_u32 s61, s73, 0
    buffer_load_dwordx4 v5, s[52:55], s61 offen lds
    s_add_u32 m0, s62, 1024
    s_add_u32 s61, s73, 14336
    buffer_load_dwordx4 v5, s[52:55], s61 offen lds
    s_add_u32 m0, s62, 2048
    s_add_u32 s61, s73, 25088
    buffer_load_dwordx4 v5, s[52:55], s61 offen lds
    s_add_u32 m0, s62, 3072
    s_add_u32 s61, s73, 39424
    buffer_load_dwordx4 v5, s[52:55], s61 offen lds
    s_add_u32 m0, s70, s67
    s_nop 0
    buffer_load_dwordx4 v6, s[48:51], s72 offen offset:0 sc1 lds
    buffer_load_dwordx4 v6, s[48:51], s72 offen offset:1024 sc1 lds
    buffer_load_dwordx4 v6, s[48:51], s72 offen offset:2048 sc1 lds
    buffer_load_dwordx4 v6, s[48:51], s72 offen offset:3072 sc1 lds
    s_add_u32 s72, s72, 8192
    s_add_u32 s73, s73, 100352
    s_add_u32 s67, s67, 32768
    s_and_b32 s67, s67, 0x1ffff
    s_add_u32 s62, s71, s67
    s_add_u32 m0, s62, 0
    s_add_u32 s61, s73, 0
    buffer_load_dwordx4 v5, s[52:55], s61 offen lds
    s_add_u32 m0, s62, 1024
    s_add_u32 s61, s73, 14336
    buffer_load_dwordx4 v5, s[52:55], s61 offen lds
    s_add_u32 m0, s62, 2048
    s_add_u32 s61, s73, 25088
    buffer_load_dwordx4 v5, s[52:55], s61 offen lds
    s_add_u32 m0, s62, 3072
    s_add_u32 s61, s73, 39424
    buffer_load_dwordx4 v5, s[52:55], s61 offen lds
    s_add_u32 m0, s70, s67
    s_nop 0
    buffer_load_dwordx4 v6, s[48:51], s72 offen offset:0 sc1 lds
    buffer_load_dwordx4 v6, s[48:51], s72 offen offset:1024 sc1 lds
    buffer_load_dwordx4 v6, s[48:51], s72 offen offset:2048 sc1 lds
    buffer_load_dwordx4 v6, s[48:51], s72 offen offset:3072 sc1 lds
    s_add_u32 s72, s72, 8192
    s_add_u32 s73, s73, 100352
    s_add_u32 s67, s67, 32768
    s_and_b32 s67, s67, 0x1ffff
    s_add_u32 s62, s71, s67
    s_add_u32 m0, s62, 0
    s_add_u32 s61, s73, 0
    buffer_load_dwordx4 v5, s[52:55], s61 offen lds
    s_add_u32 m0, s62, 1024
    s_add_u32 s61, s73, 14336
    buffer_load_dwordx4 v5, s[52:55], s61 offen lds
    s_add_u32 m0, s62, 2048
    s_add_u32 s61, s73, 25088
    buffer_load_dwordx4 v5, s[52:55], s61 offen lds
    s_add_u32 m0, s62, 3072
    s_add_u32 s61, s73, 39424
    buffer_load_dwordx4 v5, s[52:55], s61 offen lds
    s_add_u32 m0, s70, s67
    s_nop 0
    buffer_load_dwordx4 v6, s[48:51], s72 offen offset:0 sc1 lds
    buffer_load_dwordx4 v6, s[48:51], s72 offen offset:1024 sc1 lds
    buffer_load_dwordx4 v6, s[48:51], s72 offen offset:2048 sc1 lds
    buffer_load_dwordx4 v6, s[48:51], s72 offen offset:3072 sc1 lds
    s_add_u32 s72, s72, 8192
    s_add_u32 s73, s73, 100352
    s_add_u32 s67, s67, 32768
    s_and_b32 s67, s67, 0x1ffff
    s_waitcnt vmcnt(16)
    s_barrier
    s_add_u32 s62, s71, s67
    s_add_u32 m0, s62, 0
    s_add_u32 s61, s73, 0
    buffer_load_dwordx4 v5, s[52:55], s61 offen lds
    s_add_u32 m0, s62, 1024
    s_add_u32 s61, s73, 14336
    buffer_load_dwordx4 v5, s[52:55], s61 offen lds
    s_add_u32 m0, s62, 2048
    s_add_u32 s61, s73, 25088
    buffer_load_dwordx4 v5, s[52:55], s61 offen lds
    s_add_u32 m0, s62, 3072
    s_add_u32 s61, s73, 39424
    buffer_load_dwordx4 v5, s[52:55], s61 offen lds
    s_add_u32 m0, s70, s67
    s_nop 0
    buffer_load_dwordx4 v6, s[48:51], s72 offen offset:0 sc1 lds
    buffer_load_dwordx4 v6, s[48:51], s72 offen offset:1024 sc1 lds
    buffer_load_dwordx4 v6, s[48:51], s72 offen offset:2048 sc1 lds
    buffer_load_dwordx4 v6, s[48:51], s72 offen offset:3072 sc1 lds
    s_add_u32 s72, s72, 8192
    s_add_u32 s73, s73, 100352
    s_add_u32 s67, s67, 32768
    s_and_b32 s67, s67, 0x1ffff
    s_cmp_eq_u32 s60, 0
    s_cbranch_scc0 K4_ready
    s_lshr_b32 s61, s63, 1
    s_lshl_b32 s61, s61, 7
    s_add_u32 s61, s61, 24207360
    v_lshlrev_b32 v10, 2, v1
    v_cmp_gt_u32 vcc, 28, v1
    s_nop 1
    v_cndmask_b32 v11, 0, v10, vcc
    v_add_u32 v11, s61, v11
    s_lshl_b32 s61, s63, 3
    s_add_u32 s61, s61, 24186880
    v_mov_b32 v12, s61
    v_cmp_eq_u32 vcc, 28, v1
    s_nop 1
    v_cndmask_b32 v11, v11, v12, vcc
    s_mul_i32 s61, s63, 7
    s_add_u32 s61, s61, s64
    s_lshl_b32 s61, s61, 4
    s_add_u32 s61, s61, 24190860
    v_add_u32 v12, s61, v10
    v_subrev_u32 v10, 29, v1
    v_cmp_gt_u32 vcc, 4, v10
    s_nop 1
    v_cndmask_b32 v11, v11, v12, vcc
    s_mov_b32 s77, 0
K4h_poll:
    buffer_load_dword v12, v11, s[48:51], 0 offen sc1
    s_waitcnt vmcnt(0)
    v_cmp_ne_u32 vcc, s95, v12
    s_cbranch_vccz K4h_ok
    s_sleep 3
    s_add_u32 s77, s77, 1
    s_cmp_lt_u32 s77, 0x80000
    s_cbranch_scc1 K4h_poll
K4h_ok:
K4_ready:
    s_mov_b32 s68, 1
K4_ld1:
    s_waitcnt vmcnt(16)
    s_barrier
    s_lshl_b32 s61, s74, 13
    s_add_u32 s78, s65, s61
    s_mul_i32 s61, s74, 114688
    s_add_u32 s79, s66, s61
    s_add_u32 s74, s74, 1
    s_cmp_lt_u32 s74, 14
    s_cselect_b32 s74, s74, 0
    s_add_u32 s62, s71, s67
    s_add_u32 m0, s62, 0
    s_add_u32 s61, s79, 0
    buffer_load_dwordx4 v5, s[44:47], s61 offen lds
    s_add_u32 m0, s62, 1024
    s_add_u32 s61, s79, 14336
    buffer_load_dwordx4 v5, s[44:47], s61 offen lds
    s_add_u32 m0, s62, 2048
    s_add_u32 s61, s79, 28672
    buffer_load_dwordx4 v5, s[44:47], s61 offen lds
    s_add_u32 m0, s62, 3072
    s_add_u32 s61, s79, 43008
    buffer_load_dwordx4 v5, s[44:47], s61 offen lds
    s_add_u32 m0, s70, s67
    s_nop 0
    buffer_load_dwordx4 v6, s[48:51], s78 offen offset:0 sc1 lds
    buffer_load_dwordx4 v6, s[48:51], s78 offen offset:1024 sc1 lds
    buffer_load_dwordx4 v6, s[48:51], s78 offen offset:2048 sc1 lds
    buffer_load_dwordx4 v6, s[48:51], s78 offen offset:3072 sc1 lds
    s_add_u32 s67, s67, 32768
    s_and_b32 s67, s67, 0x1ffff
    s_add_u32 s68, s68, 1
    s_cmp_lt_u32 s68, 15
    s_cbranch_scc1 K4_ld1
    s_waitcnt vmcnt(16)
    s_barrier
    s_waitcnt vmcnt(8)
    s_barrier
    s_waitcnt vmcnt(0)
    s_barrier
    s_endpgm
K4_pub:
    s_waitcnt vmcnt(0)
    s_lshl_b32 s61, s75, 2
    s_add_u32 s61, s61, 156672
    v_mov_b32 v10, s61
    v_mov_b32 v11, 1
    v_cmp_eq_u32 vcc, 0, v1
    s_and_saveexec_b64 s[52:53], vcc
    ds_add_rtn_u32 v12, v10, v11
    s_waitcnt lgkmcnt(0)
    v_readfirstlane_b32 s61, v12
    s_cmp_eq_u32 s61, 3
    s_cbranch_scc0 K4_nopub
    s_lshl_b32 s62, s90, 7
    s_lshl_b32 s61, s91, 3
    s_add_u32 s62, s62, s61
    s_lshl_b32 s61, s75, 2
    s_add_u32 s62, s62, s61
    s_add_u32 s62, s62, 24207360
    v_mov_b32 v10, s95
    v_mov_b32 v11, 0
    buffer_store_dword v10, v11, s[48:51], s62 offen sc1
K4_nopub:
    s_mov_b64 exec, s[52:53]
    s_cmp_eq_u32 s75, 0
    s_cbranch_scc1 K4_comp
    s_endpgm
K4_comp:
    s_mov_b32 s56, s34
    s_mov_b32 s57, s35
    s_mov_b32 s58, 1835008
    s_mov_b32 s59, 0x00020000
    s_and_b32 s61, s60, 1
    s_lshl_b32 s61, s61, 13
    v_add_u32 v8, s61, v6
    s_lshr_b32 s61, s60, 1
    s_lshl_b32 s61, s61, 13
    s_add_u32 s61, s61, 16384
    v_add_u32 v4, s61, v4
    s_mov_b32 s68, 0
    v_mov_b32 v88, 0
    v_mov_b32 v104, 0
    v_mov_b32 v89, 0
    v_mov_b32 v105, 0
    v_mov_b32 v90, 0
    v_mov_b32 v106, 0
    v_mov_b32 v91, 0
    v_mov_b32 v107, 0
    v_mov_b32 v92, 0
    v_mov_b32 v108, 0
    v_mov_b32 v93, 0
    v_mov_b32 v109, 0
    v_mov_b32 v94, 0
    v_mov_b32 v110, 0
    v_mov_b32 v95, 0
    v_mov_b32 v111, 0
    v_mov_b32 v96, 0
    v_mov_b32 v112, 0
    v_mov_b32 v97, 0
    v_mov_b32 v113, 0
    v_mov_b32 v98, 0
    v_mov_b32 v114, 0
    v_mov_b32 v99, 0
    v_mov_b32 v115, 0
    v_mov_b32 v100, 0
    v_mov_b32 v116, 0
    v_mov_b32 v101, 0
    v_mov_b32 v117, 0
    v_mov_b32 v102, 0
    v_mov_b32 v118, 0
    v_mov_b32 v103, 0
    v_mov_b32 v119, 0
    s_mov_b32 s69, 0
K4_c2:
    s_barrier
    v_add_u32 v9, s68, v8
    v_add_u32 v7, s68, v4
    ds_read_b128 v[24:27], v9 offset:0
    ds_read_b64_tr_b16 v[56:57], v7 offset:0
    ds_read_b64_tr_b16 v[58:59], v7 offset:512
    ds_read_b128 v[28:31], v9 offset:1024
    ds_read_b64_tr_b16 v[60:61], v7 offset:1024
    ds_read_b64_tr_b16 v[62:63], v7 offset:1536
    ds_read_b128 v[32:35], v9 offset:2048
    ds_read_b64_tr_b16 v[64:65], v7 offset:2048
    ds_read_b64_tr_b16 v[66:67], v7 offset:2560
    ds_read_b128 v[36:39], v9 offset:3072
    ds_read_b64_tr_b16 v[68:69], v7 offset:3072
    ds_read_b64_tr_b16 v[70:71], v7 offset:3584
    s_waitcnt lgkmcnt(9)
    v_mfma_f32_32x32x16_bf16 v[104:119], v[56:59], v[24:27], v[104:119]
    ds_read_b128 v[40:43], v9 offset:4096
    ds_read_b64_tr_b16 v[72:73], v7 offset:4096
    ds_read_b64_tr_b16 v[74:75], v7 offset:4608
    s_waitcnt lgkmcnt(9)
    v_mfma_f32_32x32x16_bf16 v[104:119], v[60:63], v[28:31], v[104:119]
    ds_read_b128 v[44:47], v9 offset:5120
    ds_read_b64_tr_b16 v[76:77], v7 offset:5120
    ds_read_b64_tr_b16 v[78:79], v7 offset:5632
    s_waitcnt lgkmcnt(9)
    v_mfma_f32_32x32x16_bf16 v[104:119], v[64:67], v[32:35], v[104:119]
    ds_read_b128 v[48:51], v9 offset:6144
    ds_read_b64_tr_b16 v[80:81], v7 offset:6144
    ds_read_b64_tr_b16 v[82:83], v7 offset:6656
    s_waitcnt lgkmcnt(9)
    v_mfma_f32_32x32x16_bf16 v[104:119], v[68:71], v[36:39], v[104:119]
    ds_read_b128 v[52:55], v9 offset:7168
    ds_read_b64_tr_b16 v[84:85], v7 offset:7168
    ds_read_b64_tr_b16 v[86:87], v7 offset:7680
    s_waitcnt lgkmcnt(9)
    v_mfma_f32_32x32x16_bf16 v[104:119], v[72:75], v[40:43], v[104:119]
    s_waitcnt lgkmcnt(6)
    v_mfma_f32_32x32x16_bf16 v[104:119], v[76:79], v[44:47], v[104:119]
    s_waitcnt lgkmcnt(3)
    v_mfma_f32_32x32x16_bf16 v[104:119], v[80:83], v[48:51], v[104:119]
    s_waitcnt lgkmcnt(0)
    v_mfma_f32_32x32x16_bf16 v[104:119], v[84:87], v[52:55], v[104:119]
    s_add_u32 s68, s68, 32768
    s_and_b32 s68, s68, 0x1ffff
    s_add_u32 s69, s69, 1
    s_cmp_lt_u32 s69, 4
    s_cbranch_scc1 K4_c2
    s_lshl_b32 s61, s63, 1
    s_and_b32 s62, s60, 1
    s_add_u32 s61, s61, s62
    s_lshl_b32 s62, s61, 7
    s_add_u32 s62, s62, 8388608
    v_lshlrev_b32 v10, 2, v3
    buffer_load_dword v13, v10, s[48:51], s62 offen sc1
    s_mul_i32 s61, s61, 28672
    s_lshl_b32 s62, s64, 12
    s_add_u32 s61, s61, s62
    s_lshr_b32 s62, s60, 1
    s_lshl_b32 s62, s62, 11
    s_add_u32 s61, s61, s62
    s_add_u32 s61, s61, 11534336
    buffer_load_dwordx4 v[16:19], v6, s[48:51], s61 offen sc1
    buffer_load_dwordx4 v[20:23], v6, s[48:51], s61 offen offset:1024 sc1
K4_c1:
    s_barrier
    v_add_u32 v9, s68, v8
    v_add_u32 v7, s68, v4
    ds_read_b128 v[24:27], v9 offset:0
    ds_read_b64_tr_b16 v[56:57], v7 offset:0
    ds_read_b64_tr_b16 v[58:59], v7 offset:512
    ds_read_b128 v[28:31], v9 offset:1024
    ds_read_b64_tr_b16 v[60:61], v7 offset:1024
    ds_read_b64_tr_b16 v[62:63], v7 offset:1536
    ds_read_b128 v[32:35], v9 offset:2048
    ds_read_b64_tr_b16 v[64:65], v7 offset:2048
    ds_read_b64_tr_b16 v[66:67], v7 offset:2560
    ds_read_b128 v[36:39], v9 offset:3072
    ds_read_b64_tr_b16 v[68:69], v7 offset:3072
    ds_read_b64_tr_b16 v[70:71], v7 offset:3584
    s_waitcnt lgkmcnt(9)
    v_mfma_f32_32x32x16_bf16 v[88:103], v[56:59], v[24:27], v[88:103]
    ds_read_b128 v[40:43], v9 offset:4096
    ds_read_b64_tr_b16 v[72:73], v7 offset:4096
    ds_read_b64_tr_b16 v[74:75], v7 offset:4608
    s_waitcnt lgkmcnt(9)
    v_mfma_f32_32x32x16_bf16 v[88:103], v[60:63], v[28:31], v[88:103]
    ds_read_b128 v[44:47], v9 offset:5120
    ds_read_b64_tr_b16 v[76:77], v7 offset:5120
    ds_read_b64_tr_b16 v[78:79], v7 offset:5632
    s_waitcnt lgkmcnt(9)
    v_mfma_f32_32x32x16_bf16 v[88:103], v[64:67], v[32:35], v[88:103]
    ds_read_b128 v[48:51], v9 offset:6144
    ds_read_b64_tr_b16 v[80:81], v7 offset:6144
    ds_read_b64_tr_b16 v[82:83], v7 offset:6656
    s_waitcnt lgkmcnt(9)
    v_mfma_f32_32x32x16_bf16 v[88:103], v[68:71], v[36:39], v[88:103]
    ds_read_b128 v[52:55], v9 offset:7168
    ds_read_b64_tr_b16 v[84:85], v7 offset:7168
    ds_read_b64_tr_b16 v[86:87], v7 offset:7680
    s_waitcnt lgkmcnt(9)
    v_mfma_f32_32x32x16_bf16 v[88:103], v[72:75], v[40:43], v[88:103]
    s_waitcnt lgkmcnt(6)
    v_mfma_f32_32x32x16_bf16 v[88:103], v[76:79], v[44:47], v[88:103]
    s_waitcnt lgkmcnt(3)
    v_mfma_f32_32x32x16_bf16 v[88:103], v[80:83], v[48:51], v[88:103]
    s_waitcnt lgkmcnt(0)
    v_mfma_f32_32x32x16_bf16 v[88:103], v[84:87], v[52:55], v[88:103]
    s_add_u32 s68, s68, 32768
    s_and_b32 s68, s68, 0x1ffff
    s_add_u32 s69, s69, 1
    s_cmp_lt_u32 s69, 18
    s_cbranch_scc1 K4_c1
    s_waitcnt vmcnt(0)
    s_nop 12
    v_sub_f32 v12, 1.0, v13
    v_lshlrev_b32 v10, 16, v16
    v_and_b32 v11, 0xffff0000, v16
    v_add_f32 v88, v88, v10
    v_add_f32 v89, v89, v11
    v_lshlrev_b32 v10, 16, v17
    v_and_b32 v11, 0xffff0000, v17
    v_add_f32 v90, v90, v10
    v_add_f32 v91, v91, v11
    v_lshlrev_b32 v10, 16, v18
    v_and_b32 v11, 0xffff0000, v18
    v_add_f32 v92, v92, v10
    v_add_f32 v93, v93, v11
    v_lshlrev_b32 v10, 16, v19
    v_and_b32 v11, 0xffff0000, v19
    v_add_f32 v94, v94, v10
    v_add_f32 v95, v95, v11
    v_lshlrev_b32 v10, 16, v20
    v_and_b32 v11, 0xffff0000, v20
    v_add_f32 v96, v96, v10
    v_add_f32 v97, v97, v11
    v_lshlrev_b32 v10, 16, v21
    v_and_b32 v11, 0xffff0000, v21
    v_add_f32 v98, v98, v10
    v_add_f32 v99, v99, v11
    v_lshlrev_b32 v10, 16, v22
    v_and_b32 v11, 0xffff0000, v22
    v_add_f32 v100, v100, v10
    v_add_f32 v101, v101, v11
    v_lshlrev_b32 v10, 16, v23
    v_and_b32 v11, 0xffff0000, v23
    v_add_f32 v102, v102, v10
    v_add_f32 v103, v103, v11
    v_mul_f32 v88, v88, v12
    v_mul_f32 v89, v89, v12
    v_mul_f32 v90, v90, v12
    v_mul_f32 v91, v91, v12
    v_mul_f32 v92, v92, v12
    v_mul_f32 v93, v93, v12
    v_mul_f32 v94, v94, v12
    v_mul_f32 v95, v95, v12
    v_mul_f32 v96, v96, v12
    v_mul_f32 v97, v97, v12
    v_mul_f32 v98, v98, v12
    v_mul_f32 v99, v99, v12
    v_mul_f32 v100, v100, v12
    v_mul_f32 v101, v101, v12
    v_mul_f32 v102, v102, v12
    v_mul_f32 v103, v103, v12
    v_fmac_f32 v88, v104, v13
    v_fmac_f32 v89, v105, v13
    v_fmac_f32 v90, v106, v13
    v_fmac_f32 v91, v107, v13
    v_fmac_f32 v92, v108, v13
    v_fmac_f32 v93, v109, v13
    v_fmac_f32 v94, v110, v13
    v_fmac_f32 v95, v111, v13
    v_fmac_f32 v96, v112, v13
    v_fmac_f32 v97, v113, v13
    v_fmac_f32 v98, v114, v13
    v_fmac_f32 v99, v115, v13
    v_fmac_f32 v100, v116, v13
    v_fmac_f32 v101, v117, v13
    v_fmac_f32 v102, v118, v13
    v_fmac_f32 v103, v119, v13
    v_cvt_pk_bf16_f32 v120, v88, v89
    v_cvt_pk_bf16_f32 v121, v90, v91
    v_cvt_pk_bf16_f32 v122, v92, v93
    v_cvt_pk_bf16_f32 v123, v94, v95
    v_cvt_pk_bf16_f32 v124, v96, v97
    v_cvt_pk_bf16_f32 v125, v98, v99
    v_cvt_pk_bf16_f32 v126, v100, v101
    v_cvt_pk_bf16_f32 v127, v102, v103
    s_lshl_b32 s61, s63, 6
    s_and_b32 s62, s60, 1
    s_lshl_b32 s62, s62, 5
    s_add_u32 s61, s61, s62
    v_add_u32 v10, s61, v3
    v_mul_u32_u24 v10, 896, v10
    v_lshl_add_u32 v10, v2, 3, v10
    s_lshl_b32 s61, s64, 7
    s_lshr_b32 s62, s60, 1
    s_lshl_b32 s62, s62, 6
    s_add_u32 s61, s61, s62
    buffer_store_dwordx2 v[120:121], v10, s[56:59], s61 offen offset:0
    buffer_store_dwordx2 v[122:123], v10, s[56:59], s61 offen offset:16
    buffer_store_dwordx2 v[124:125], v10, s[56:59], s61 offen offset:32
    buffer_store_dwordx2 v[126:127], v10, s[56:59], s61 offen offset:48
K3_exit:
    s_endpgm
K1_exit:
    s_endpgm
.section .rodata,"a"
.p2align 6
.amdhsa_kernel k1_kernel
  .amdhsa_next_free_vgpr 168
  .amdhsa_next_free_sgpr 102
  .amdhsa_accum_offset 168
  .amdhsa_group_segment_fixed_size 0
  .amdhsa_kernarg_size 96
  .amdhsa_user_sgpr_count 2
  .amdhsa_user_sgpr_kernarg_segment_ptr 1
  .amdhsa_system_sgpr_workgroup_id_x 1
.end_amdhsa_kernel
```
